```python
import torch

def _softmax(x, axis=-1):
    return torch.softmax(x, dim=axis)
def _gelu(x):
    return torch.nn.functional.gelu(x, approximate="tanh")
def _silu(x):
    return torch.nn.functional.silu(x)
def _sigmoid(x):
    return torch.sigmoid(x)
def _layernorm(x, axis=-1, eps=1e-5):
    m = x.mean(dim=axis, keepdim=True)
    v = x.var(dim=axis, keepdim=True, unbiased=False)
    return (x - m) / torch.sqrt(v + eps)
def _scatter_add(tgt, idx, src, axis=0):
    return tgt.clone().index_add_(axis, idx, src)
def _segment_sum(src, seg, n):
    out = torch.zeros((n,) + src.shape[1:], dtype=src.dtype)
    return out.index_add_(0, seg, src)
def _pad(x, pw):
    flat = tuple(v for pair in reversed(pw) for v in pair)
    return torch.nn.functional.pad(x, flat)

kernel_name = 'standalone__gqa_block_cached__sampling'

def setup_inputs():

    _w = (lambda a: (lambda t: t.to(torch.bfloat16) if t.is_floating_point() else t)(torch.as_tensor(a)))
    B, Sq, D = 8, 1, 512
    Hq, Hkv, Sk, Dh = 32, 8, 8192, 128
    assert Hq % Hkv == 0, (Hq, Hkv)
    return {
        "x": _w((lambda *s: torch.randn(*s, dtype=torch.bfloat16) * 0.8)(B, Sq, D)),
        "k_cache": _w((lambda *s: torch.randn(*s, dtype=torch.bfloat16) * 0.8)(B, Hkv, Sk, Dh)),
        "v_cache": _w((lambda *s: torch.randn(*s, dtype=torch.bfloat16) * 0.05)(B, Hkv, Sk, Dh)),
        "wq": _w((lambda *s: torch.randn(*s, dtype=torch.bfloat16) * 0.8)(D, Hq * Dh) * (D ** -0.5)),
        "wo": _w((lambda *s: torch.randn(*s, dtype=torch.bfloat16) * 0.05)(Hq * Dh, D) * ((Hq * Dh) ** -0.5)),
    }

def reference(x, k_cache, v_cache, wq, wo):
    B, Sq, D = x.shape
    Hq, Dh = 32, 128
    Hkv = k_cache.shape[1]
    rep = Hq // Hkv
    q = (lambda x, *d: x.permute(*d))((x @ wq).reshape(B, Sq, Hq, Dh), 0, 2, 1, 3)
    k = (lambda x, n, axis: torch.repeat_interleave(x, n, dim=axis))(k_cache, rep, axis=1)
    v = (lambda x, n, axis: torch.repeat_interleave(x, n, dim=axis))(v_cache, rep, axis=1)
    scores = torch.einsum("bhqd,bhkd->bhqk", q, k) * (Dh ** -0.5)
    p = _softmax(scores, axis=-1)
    o = torch.einsum("bhqk,bhkd->bhqd", p, v)
    return (lambda x, *d: x.permute(*d))(o, 0, 2, 1, 3).reshape(B, Sq, Hq * Dh) @ wo
```

```asm
; @launch grid=(256,1,1) block=(512,1,1) lds=143360
.amdgcn_target "amdgcn-amd-amdhsa--gfx950"
.text
.globl standalone__gqa_block_cached__sampling_kernel
.p2align 8
.type standalone__gqa_block_cached__sampling_kernel,@function
standalone__gqa_block_cached__sampling_kernel:
  s_cmp_ge_u32 s2, 256
  s_cbranch_scc1 L_end
  s_memrealtime s[92:93]
  s_load_dwordx16 s[4:19], s[0:1], 0
  v_lshrrev_b32 v1, 6, v0
  v_and_b32 v0, 63, v0
  v_readfirstlane_b32 s44, v1
  v_mov_b32 v8, 0
  v_mov_b32 v9, 0
  v_mov_b32 v10, 0
  v_mov_b32 v11, 0
  ds_write_b128 v9, v[8:11] offset:1024
  s_and_b32 s20, s2, 1
  s_bfe_u32 s21, s2, 0x10001
  s_bfe_u32 s22, s2, 0x10002
  s_lshr_b32 s23, s2, 3
  s_lshl1_add_u32 s45, s22, s20
  s_and_b32 s24, s20, s23
  s_xor_b32 s21, s21, s24
  s_lshl1_add_u32 s46, s23, s21
  s_lshl2_add_u32 s47, s46, s45
  s_bfe_u32 s24, s46, 0x10003
  s_lshl_b32 s24, s24, 1
  s_cmp_eq_u32 s24, s45
  s_cselect_b32 s43, 1, 0
  s_lshl_b32 s52, s46, 8
  s_add_u32 s52, s52, 4096
  v_lshlrev_b32 v2, 4, v0
  v_lshrrev_b32 v3, 4, v0
  v_bfe_u32 v4, v0, 2, 2
  v_and_b32 v5, 3, v0
  s_cmp_ge_u32 s44, 4
  s_cbranch_scc1 L_helper
  v_lshlrev_b32 v1, 6, v3
  v_lshl_add_u32 v1, v4, 8, v1
  v_lshl_add_u32 v1, v5, 4, v1
  s_lshl_b32 s56, s46, 21
  s_lshl2_add_u32 s57, s45, s44
  s_lshl_b32 s57, s57, 12
  s_add_u32 s48, s56, s57
  s_mov_b32 s34, 0x8000000
  s_mov_b32 s35, 0x20000
  s_mov_b32 s38, 0x8000000
  s_mov_b32 s39, 0x20000
  s_waitcnt lgkmcnt(0)
  s_mov_b64 s[32:33], s[6:7]
  s_mov_b64 s[36:37], s[8:9]
  s_cmp_eq_u32 s43, 0
  s_cbranch_scc1 L_go
  s_barrier
L_go0:
  ds_read_b32 v10, v9 offset:1024
  s_waitcnt lgkmcnt(0)
  v_readfirstlane_b32 s58, v10
  s_cmp_lt_u32 s58, 4
  s_cbranch_scc1 L_go0
L_go:
  buffer_load_dwordx4 v[64:67], v1, s[32:35], s48 offen offset:0 nt
  buffer_load_dwordx4 v[68:71], v1, s[32:35], s48 offen offset:1024 nt
  buffer_load_dwordx4 v[72:75], v1, s[32:35], s48 offen offset:2048 nt
  buffer_load_dwordx4 v[76:79], v1, s[32:35], s48 offen offset:3072 nt
  buffer_load_dwordx4 v[80:83], v2, s[36:39], s48 offen offset:0 nt
  buffer_load_dwordx4 v[84:87], v2, s[36:39], s48 offen offset:1024 nt
  s_cmp_eq_u32 s43, 0
  s_cbranch_scc0 L_noA
  s_barrier
L_noA:
  s_mov_b32 s28, s18
  s_mov_b32 s29, s19
  s_mov_b32 s30, 0x20000000
  s_mov_b32 s31, 0x20000
  s_mov_b32 s59, 1069066811
  s_mov_b32 s57, 1035273459
  v_mov_b32 v54, 0xff7fffff
  v_mov_b32 v55, 0
  v_mov_b32 v40, 0
  v_mov_b32 v41, 0
  v_mov_b32 v42, 0
  v_mov_b32 v43, 0
  v_mov_b32 v44, 0
  v_mov_b32 v45, 0
  v_mov_b32 v46, 0
  v_mov_b32 v47, 0
  v_mov_b32 v32, 0
  v_mov_b32 v33, 0
  v_mov_b32 v34, 0
  v_mov_b32 v35, 0
  v_mov_b32 v36, 0
  v_mov_b32 v37, 0
  v_mov_b32 v38, 0
  v_mov_b32 v39, 0
  s_mul_i32 s62, s44, 16384
  s_add_u32 s62, s62, 77824
  v_add_u32 v6, s62, v2
  s_lshl_b32 s55, s24, 14
  s_add_u32 s55, s55, s56
  s_add_u32 s55, s55, 1835008
  s_mul_i32 s58, s44, 2560
  v_add_u32 v60, s58, v2
  v_lshlrev_b32 v61, 3, v0
  v_add_u32 v61, s58, v61
  v_lshlrev_b32 v62, 8, v4
  v_lshl_add_u32 v62, v5, 6, v62
  v_lshl_add_u32 v62, v3, 4, v62
  v_lshlrev_b32 v63, 3, v3
  v_and_b32 v59, 15, v0
  v_lshlrev_b32 v59, 4, v59
  v_and_b32 v11, 1, v3
  v_lshl_add_u32 v59, v11, 9, v59
  v_lshrrev_b32 v11, 1, v3
  v_lshl_add_u32 v59, v11, 13, v59
  s_lshr_b32 s86, s47, 3
  s_lshl_b32 s86, s86, 14
  s_and_b32 s87, s47, 7
  s_lshl_b32 s87, s87, 10
  s_add_u32 s86, s86, s87
  s_add_u32 s86, s86, 524288
  s_waitcnt vmcnt(5)
  buffer_load_dwordx4 v[88:91], v2, s[36:39], s48 offen offset:2048 nt
  s_waitcnt vmcnt(5)
  buffer_load_dwordx4 v[92:95], v2, s[36:39], s48 offen offset:3072 nt
  s_add_u32 s48, s48, 65536
  s_waitcnt vmcnt(5)
  buffer_load_dwordx4 v[96:99], v1, s[32:35], s48 offen offset:0 nt
  s_waitcnt vmcnt(5)
  buffer_load_dwordx4 v[100:103], v1, s[32:35], s48 offen offset:1024 nt
  s_waitcnt vmcnt(5)
  buffer_load_dwordx4 v[104:107], v1, s[32:35], s48 offen offset:2048 nt
  s_waitcnt vmcnt(5)
  buffer_load_dwordx4 v[108:111], v1, s[32:35], s48 offen offset:3072 nt
  s_waitcnt vmcnt(5)
  buffer_load_dwordx4 v[112:115], v2, s[36:39], s48 offen offset:0 nt
  s_waitcnt vmcnt(5)
  buffer_load_dwordx4 v[116:119], v2, s[36:39], s48 offen offset:1024 nt
  s_waitcnt vmcnt(5)
  buffer_load_dwordx4 v[120:123], v2, s[36:39], s48 offen offset:2048 nt
  s_waitcnt vmcnt(5)
  buffer_load_dwordx4 v[124:127], v2, s[36:39], s48 offen offset:3072 nt
  s_add_u32 s48, s48, 65536
  s_waitcnt vmcnt(5)
  buffer_load_dwordx4 v[128:131], v1, s[32:35], s48 offen offset:0 nt
  s_waitcnt vmcnt(5)
  buffer_load_dwordx4 v[132:135], v1, s[32:35], s48 offen offset:1024 nt
  s_waitcnt vmcnt(5)
  buffer_load_dwordx4 v[136:139], v1, s[32:35], s48 offen offset:2048 nt
  s_waitcnt vmcnt(5)
  buffer_load_dwordx4 v[140:143], v1, s[32:35], s48 offen offset:3072 nt
  s_waitcnt vmcnt(5)
  buffer_load_dwordx4 v[144:147], v2, s[36:39], s48 offen offset:0 nt
  s_waitcnt vmcnt(5)
  buffer_load_dwordx4 v[148:151], v2, s[36:39], s48 offen offset:1024 nt
  s_waitcnt vmcnt(5)
  buffer_load_dwordx4 v[152:155], v2, s[36:39], s48 offen offset:2048 nt
  s_waitcnt vmcnt(5)
  buffer_load_dwordx4 v[156:159], v2, s[36:39], s48 offen offset:3072 nt
  s_add_u32 s48, s48, 65536
  s_waitcnt vmcnt(5)
  buffer_load_dwordx4 v[160:163], v1, s[32:35], s48 offen offset:0 nt
  s_waitcnt vmcnt(5)
  buffer_load_dwordx4 v[164:167], v1, s[32:35], s48 offen offset:1024 nt
  s_waitcnt vmcnt(5)
  buffer_load_dwordx4 v[168:171], v1, s[32:35], s48 offen offset:2048 nt
  s_waitcnt vmcnt(5)
  buffer_load_dwordx4 v[172:175], v1, s[32:35], s48 offen offset:3072 nt
  s_waitcnt vmcnt(5)
  buffer_load_dwordx4 v[176:179], v2, s[36:39], s48 offen offset:0 nt
  s_waitcnt vmcnt(5)
  buffer_load_dwordx4 v[180:183], v2, s[36:39], s48 offen offset:1024 nt
  s_waitcnt vmcnt(5)
  buffer_load_dwordx4 v[184:187], v2, s[36:39], s48 offen offset:2048 nt
  s_waitcnt vmcnt(5)
  buffer_load_dwordx4 v[188:191], v2, s[36:39], s48 offen offset:3072 nt
  s_add_u32 s48, s48, 65536
  s_waitcnt vmcnt(5)
  buffer_load_dwordx4 v[192:195], v1, s[32:35], s48 offen offset:0 nt
  s_waitcnt vmcnt(5)
  buffer_load_dwordx4 v[196:199], v1, s[32:35], s48 offen offset:1024 nt
  s_waitcnt vmcnt(5)
  buffer_load_dwordx4 v[200:203], v1, s[32:35], s48 offen offset:2048 nt
  s_waitcnt vmcnt(5)
  buffer_load_dwordx4 v[204:207], v1, s[32:35], s48 offen offset:3072 nt
  s_waitcnt vmcnt(5)
  buffer_load_dwordx4 v[208:211], v2, s[36:39], s48 offen offset:0 nt
  s_waitcnt vmcnt(5)
  buffer_load_dwordx4 v[212:215], v2, s[36:39], s48 offen offset:1024 nt
  s_waitcnt vmcnt(5)
  buffer_load_dwordx4 v[216:219], v2, s[36:39], s48 offen offset:2048 nt
  s_waitcnt vmcnt(5)
  buffer_load_dwordx4 v[220:223], v2, s[36:39], s48 offen offset:3072 nt
  s_add_u32 s48, s48, 65536
  s_waitcnt vmcnt(5)
  buffer_load_dwordx4 v[224:227], v1, s[32:35], s48 offen offset:0 nt
  s_waitcnt vmcnt(5)
  buffer_load_dwordx4 v[228:231], v1, s[32:35], s48 offen offset:1024 nt
  s_waitcnt vmcnt(5)
  buffer_load_dwordx4 v[232:235], v1, s[32:35], s48 offen offset:2048 nt
  s_waitcnt vmcnt(5)
  buffer_load_dwordx4 v[236:239], v1, s[32:35], s48 offen offset:3072 nt
  s_waitcnt vmcnt(5)
  buffer_load_dwordx4 v[240:243], v2, s[36:39], s48 offen offset:0 nt
  s_waitcnt vmcnt(5)
  buffer_load_dwordx4 v[244:247], v2, s[36:39], s48 offen offset:1024 nt
  s_waitcnt vmcnt(5)
  buffer_load_dwordx4 v[248:251], v2, s[36:39], s48 offen offset:2048 nt
  s_waitcnt vmcnt(5)
  buffer_load_dwordx4 v[252:255], v2, s[36:39], s48 offen offset:3072 nt
  s_add_u32 s48, s48, 65536
  s_add_u32 m0, s62, 0
  s_waitcnt vmcnt(5)
  buffer_load_dwordx4 v1, s[32:35], s48 offen offset:0 nt lds
  s_waitcnt vmcnt(5)
  buffer_load_dwordx4 v1, s[32:35], s48 offen offset:1024 nt lds
  s_waitcnt vmcnt(5)
  buffer_load_dwordx4 v1, s[32:35], s48 offen offset:2048 nt lds
  s_waitcnt vmcnt(5)
  buffer_load_dwordx4 v1, s[32:35], s48 offen offset:3072 nt lds
  s_add_u32 m0, s62, 4096
  s_waitcnt vmcnt(5)
  buffer_load_dwordx4 v2, s[36:39], s48 offen offset:0 nt lds
  s_waitcnt vmcnt(5)
  buffer_load_dwordx4 v2, s[36:39], s48 offen offset:1024 nt lds
  s_waitcnt vmcnt(5)
  buffer_load_dwordx4 v2, s[36:39], s48 offen offset:2048 nt lds
  s_waitcnt vmcnt(5)
  buffer_load_dwordx4 v2, s[36:39], s48 offen offset:3072 nt lds
  s_add_u32 s48, s48, 65536
  v_mov_b32 v10, 1
  ds_write_b32 v9, v10 offset:1032
  s_add_u32 m0, s62, 8192
  s_waitcnt vmcnt(5)
  buffer_load_dwordx4 v1, s[32:35], s48 offen offset:0 nt lds
  s_waitcnt vmcnt(5)
  buffer_load_dwordx4 v1, s[32:35], s48 offen offset:1024 nt lds
  s_waitcnt vmcnt(5)
  buffer_load_dwordx4 v1, s[32:35], s48 offen offset:2048 nt lds
  s_waitcnt vmcnt(5)
  buffer_load_dwordx4 v1, s[32:35], s48 offen offset:3072 nt lds
  s_add_u32 m0, s62, 12288
  s_waitcnt vmcnt(5)
  buffer_load_dwordx4 v2, s[36:39], s48 offen offset:0 nt lds
  s_waitcnt vmcnt(5)
  buffer_load_dwordx4 v2, s[36:39], s48 offen offset:1024 nt lds
  s_waitcnt vmcnt(5)
  buffer_load_dwordx4 v2, s[36:39], s48 offen offset:2048 nt lds
  s_waitcnt vmcnt(5)
  buffer_load_dwordx4 v2, s[36:39], s48 offen offset:3072 nt lds
  s_add_u32 s48, s48, 65536
L_filled:
  s_barrier
  ds_read_b128 v[12:15], v2 offset:0
  ds_read_b64 v[10:11], v9 offset:1040
  ds_read_b32 v8, v9 offset:1048
  s_waitcnt lgkmcnt(0)
  v_readfirstlane_b32 s63, v8
  v_readfirstlane_b32 s89, v10
  v_readfirstlane_b32 s91, v11
  v_xor_b32 v59, v11, v59
  v_mfma_f32_16x16x32_bf16 v[16:19], v[64:67], v[12:15], 0
  buffer_load_dwordx4 v[64:67], v1, s[32:35], s48 offen offset:0 nt
  v_mfma_f32_16x16x32_bf16 v[20:23], v[68:71], v[12:15], 0
  buffer_load_dwordx4 v[68:71], v1, s[32:35], s48 offen offset:1024 nt
  v_mfma_f32_16x16x32_bf16 v[24:27], v[72:75], v[12:15], 0
  buffer_load_dwordx4 v[72:75], v1, s[32:35], s48 offen offset:2048 nt
  v_mfma_f32_16x16x32_bf16 v[28:31], v[76:79], v[12:15], 0
  buffer_load_dwordx4 v[76:79], v1, s[32:35], s48 offen offset:3072 nt
  s_nop 4
  v_add_f32_dpp v48, v17, v16 row_ror:12 row_mask:0xf bank_mask:0x1
  v_add_f32_dpp v48, v18, v48 row_ror:8 row_mask:0xf bank_mask:0x1
  v_add_f32_dpp v48, v19, v48 row_ror:4 row_mask:0xf bank_mask:0x1
  v_add_f32_dpp v48, v22, v21 row_ror:12 row_mask:0xf bank_mask:0x2
  v_add_f32_dpp v48, v23, v48 row_ror:8 row_mask:0xf bank_mask:0x2
  v_add_f32_dpp v48, v20, v48 row_ror:4 row_mask:0xf bank_mask:0x2
  v_add_f32_dpp v48, v27, v26 row_ror:12 row_mask:0xf bank_mask:0x4
  v_add_f32_dpp v48, v24, v48 row_ror:8 row_mask:0xf bank_mask:0x4
  v_add_f32_dpp v48, v25, v48 row_ror:4 row_mask:0xf bank_mask:0x4
  v_add_f32_dpp v48, v28, v31 row_ror:12 row_mask:0xf bank_mask:0x8
  v_add_f32_dpp v48, v29, v48 row_ror:8 row_mask:0xf bank_mask:0x8
  v_add_f32_dpp v48, v30, v48 row_ror:4 row_mask:0xf bank_mask:0x8
  v_cvt_pk_bf16_f32 v48, 0, v48
  v_mul_f32 v48, s57, v48
  v_cvt_pk_bf16_f32 v48, 0, v48
  v_mul_f32 v49, s59, v48
  v_cmp_gt_f32 vcc, v49, v54
  s_cbranch_vccz L_nors0
  v_max_f32_dpp v49, v49, v49 row_ror:4 row_mask:0xf bank_mask:0xf
  s_nop 1
  v_max_f32_dpp v49, v49, v49 row_ror:8 row_mask:0xf bank_mask:0xf
  v_mov_b32 v50, v49
  s_nop 1
  v_permlane16_swap_b32 v49, v50
  v_max_f32 v49, v49, v50
  v_mov_b32 v50, v49
  s_nop 1
  v_permlane32_swap_b32 v49, v50
  v_max_f32 v49, v49, v50
  v_max_f32 v49, v49, v54
  v_sub_f32 v56, v54, v49
  v_exp_f32 v56, v56
  v_mov_b32 v54, v49
  v_mul_f32 v55, v55, v56
  v_mul_f32 v40, v40, v56
  v_mul_f32 v41, v41, v56
  v_mul_f32 v42, v42, v56
  v_mul_f32 v43, v43, v56
  v_mul_f32 v44, v44, v56
  v_mul_f32 v45, v45, v56
  v_mul_f32 v46, v46, v56
  v_mul_f32 v47, v47, v56
L_nors0:
  v_fma_f32 v48, v48, s59, -v54
  v_exp_f32 v48, v48
  s_nop 0
  v_cvt_pk_bf16_f32 v51, v48, 0
  v_cvt_pk_bf16_f32 v52, 0, v48
  v_add_f32 v55, v55, v48
  v_mov_b32_dpp v32, v51 quad_perm:[0,1,2,3] row_mask:0xf bank_mask:0x1
  v_mov_b32_dpp v32, v52 row_ror:4 row_mask:0xf bank_mask:0x2
  v_mov_b32_dpp v33, v51 row_ror:8 row_mask:0xf bank_mask:0x4
  v_mov_b32_dpp v33, v52 row_ror:12 row_mask:0xf bank_mask:0x8
  v_mov_b32_dpp v34, v51 row_ror:12 row_mask:0xf bank_mask:0x1
  v_mov_b32_dpp v34, v52 quad_perm:[0,1,2,3] row_mask:0xf bank_mask:0x2
  v_mov_b32_dpp v35, v51 row_ror:4 row_mask:0xf bank_mask:0x4
  v_mov_b32_dpp v35, v52 row_ror:8 row_mask:0xf bank_mask:0x8
  v_mfma_f32_16x16x16_bf16 v[40:43], v[80:81], v[32:33], v[40:43]
  v_mfma_f32_16x16x16_bf16 v[44:47], v[82:83], v[32:33], v[44:47]
  buffer_load_dwordx4 v[80:83], v2, s[36:39], s48 offen offset:0 nt
  v_mov_b32_dpp v36, v51 row_ror:8 row_mask:0xf bank_mask:0x1
  v_mov_b32_dpp v36, v52 row_ror:12 row_mask:0xf bank_mask:0x2
  v_mov_b32_dpp v37, v51 quad_perm:[0,1,2,3] row_mask:0xf bank_mask:0x4
  v_mov_b32_dpp v37, v52 row_ror:4 row_mask:0xf bank_mask:0x8
  v_mfma_f32_16x16x16_bf16 v[40:43], v[84:85], v[34:35], v[40:43]
  v_mfma_f32_16x16x16_bf16 v[44:47], v[86:87], v[34:35], v[44:47]
  buffer_load_dwordx4 v[84:87], v2, s[36:39], s48 offen offset:1024 nt
  v_mov_b32_dpp v38, v51 row_ror:4 row_mask:0xf bank_mask:0x1
  v_mov_b32_dpp v38, v52 row_ror:8 row_mask:0xf bank_mask:0x2
  v_mov_b32_dpp v39, v51 row_ror:12 row_mask:0xf bank_mask:0x4
  v_mov_b32_dpp v39, v52 quad_perm:[0,1,2,3] row_mask:0xf bank_mask:0x8
  v_mfma_f32_16x16x16_bf16 v[40:43], v[88:89], v[36:37], v[40:43]
  v_mfma_f32_16x16x16_bf16 v[44:47], v[90:91], v[36:37], v[44:47]
  buffer_load_dwordx4 v[88:91], v2, s[36:39], s48 offen offset:2048 nt
  v_mfma_f32_16x16x16_bf16 v[40:43], v[92:93], v[38:39], v[40:43]
  v_mfma_f32_16x16x16_bf16 v[44:47], v[94:95], v[38:39], v[44:47]
  buffer_load_dwordx4 v[92:95], v2, s[36:39], s48 offen offset:3072 nt
  s_add_u32 s48, s48, 65536
  v_mfma_f32_16x16x32_bf16 v[16:19], v[96:99], v[12:15], 0
  buffer_load_dwordx4 v[96:99], v1, s[32:35], s48 offen offset:0 nt
  v_mfma_f32_16x16x32_bf16 v[20:23], v[100:103], v[12:15], 0
  buffer_load_dwordx4 v[100:103], v1, s[32:35], s48 offen offset:1024 nt
  v_mfma_f32_16x16x32_bf16 v[24:27], v[104:107], v[12:15], 0
  buffer_load_dwordx4 v[104:107], v1, s[32:35], s48 offen offset:2048 nt
  v_mfma_f32_16x16x32_bf16 v[28:31], v[108:111], v[12:15], 0
  buffer_load_dwordx4 v[108:111], v1, s[32:35], s48 offen offset:3072 nt
  s_nop 4
  v_add_f32_dpp v48, v17, v16 row_ror:12 row_mask:0xf bank_mask:0x1
  v_add_f32_dpp v48, v18, v48 row_ror:8 row_mask:0xf bank_mask:0x1
  v_add_f32_dpp v48, v19, v48 row_ror:4 row_mask:0xf bank_mask:0x1
  v_add_f32_dpp v48, v22, v21 row_ror:12 row_mask:0xf bank_mask:0x2
  v_add_f32_dpp v48, v23, v48 row_ror:8 row_mask:0xf bank_mask:0x2
  v_add_f32_dpp v48, v20, v48 row_ror:4 row_mask:0xf bank_mask:0x2
  v_add_f32_dpp v48, v27, v26 row_ror:12 row_mask:0xf bank_mask:0x4
  v_add_f32_dpp v48, v24, v48 row_ror:8 row_mask:0xf bank_mask:0x4
  v_add_f32_dpp v48, v25, v48 row_ror:4 row_mask:0xf bank_mask:0x4
  v_add_f32_dpp v48, v28, v31 row_ror:12 row_mask:0xf bank_mask:0x8
  v_add_f32_dpp v48, v29, v48 row_ror:8 row_mask:0xf bank_mask:0x8
  v_add_f32_dpp v48, v30, v48 row_ror:4 row_mask:0xf bank_mask:0x8
  v_cvt_pk_bf16_f32 v48, 0, v48
  v_mul_f32 v48, s57, v48
  v_cvt_pk_bf16_f32 v48, 0, v48
  v_mul_f32 v49, s59, v48
  v_cmp_gt_f32 vcc, v49, v54
  s_cbranch_vccz L_nors1
  v_max_f32_dpp v49, v49, v49 row_ror:4 row_mask:0xf bank_mask:0xf
  s_nop 1
  v_max_f32_dpp v49, v49, v49 row_ror:8 row_mask:0xf bank_mask:0xf
  v_mov_b32 v50, v49
  s_nop 1
  v_permlane16_swap_b32 v49, v50
  v_max_f32 v49, v49, v50
  v_mov_b32 v50, v49
  s_nop 1
  v_permlane32_swap_b32 v49, v50
  v_max_f32 v49, v49, v50
  v_max_f32 v49, v49, v54
  v_sub_f32 v56, v54, v49
  v_exp_f32 v56, v56
  v_mov_b32 v54, v49
  v_mul_f32 v55, v55, v56
  v_mul_f32 v40, v40, v56
  v_mul_f32 v41, v41, v56
  v_mul_f32 v42, v42, v56
  v_mul_f32 v43, v43, v56
  v_mul_f32 v44, v44, v56
  v_mul_f32 v45, v45, v56
  v_mul_f32 v46, v46, v56
  v_mul_f32 v47, v47, v56
L_nors1:
  v_fma_f32 v48, v48, s59, -v54
  v_exp_f32 v48, v48
  s_nop 0
  v_cvt_pk_bf16_f32 v51, v48, 0
  v_cvt_pk_bf16_f32 v52, 0, v48
  v_add_f32 v55, v55, v48
  v_mov_b32_dpp v32, v51 quad_perm:[0,1,2,3] row_mask:0xf bank_mask:0x1
  v_mov_b32_dpp v32, v52 row_ror:4 row_mask:0xf bank_mask:0x2
  v_mov_b32_dpp v33, v51 row_ror:8 row_mask:0xf bank_mask:0x4
  v_mov_b32_dpp v33, v52 row_ror:12 row_mask:0xf bank_mask:0x8
  v_mov_b32_dpp v34, v51 row_ror:12 row_mask:0xf bank_mask:0x1
  v_mov_b32_dpp v34, v52 quad_perm:[0,1,2,3] row_mask:0xf bank_mask:0x2
  v_mov_b32_dpp v35, v51 row_ror:4 row_mask:0xf bank_mask:0x4
  v_mov_b32_dpp v35, v52 row_ror:8 row_mask:0xf bank_mask:0x8
  v_mfma_f32_16x16x16_bf16 v[40:43], v[112:113], v[32:33], v[40:43]
  v_mfma_f32_16x16x16_bf16 v[44:47], v[114:115], v[32:33], v[44:47]
  buffer_load_dwordx4 v[112:115], v2, s[36:39], s48 offen offset:0 nt
  v_mov_b32_dpp v36, v51 row_ror:8 row_mask:0xf bank_mask:0x1
  v_mov_b32_dpp v36, v52 row_ror:12 row_mask:0xf bank_mask:0x2
  v_mov_b32_dpp v37, v51 quad_perm:[0,1,2,3] row_mask:0xf bank_mask:0x4
  v_mov_b32_dpp v37, v52 row_ror:4 row_mask:0xf bank_mask:0x8
  v_mfma_f32_16x16x16_bf16 v[40:43], v[116:117], v[34:35], v[40:43]
  v_mfma_f32_16x16x16_bf16 v[44:47], v[118:119], v[34:35], v[44:47]
  buffer_load_dwordx4 v[116:119], v2, s[36:39], s48 offen offset:1024 nt
  v_mov_b32_dpp v38, v51 row_ror:4 row_mask:0xf bank_mask:0x1
  v_mov_b32_dpp v38, v52 row_ror:8 row_mask:0xf bank_mask:0x2
  v_mov_b32_dpp v39, v51 row_ror:12 row_mask:0xf bank_mask:0x4
  v_mov_b32_dpp v39, v52 quad_perm:[0,1,2,3] row_mask:0xf bank_mask:0x8
  v_mfma_f32_16x16x16_bf16 v[40:43], v[120:121], v[36:37], v[40:43]
  v_mfma_f32_16x16x16_bf16 v[44:47], v[122:123], v[36:37], v[44:47]
  buffer_load_dwordx4 v[120:123], v2, s[36:39], s48 offen offset:2048 nt
  v_mfma_f32_16x16x16_bf16 v[40:43], v[124:125], v[38:39], v[40:43]
  v_mfma_f32_16x16x16_bf16 v[44:47], v[126:127], v[38:39], v[44:47]
  buffer_load_dwordx4 v[124:127], v2, s[36:39], s48 offen offset:3072 nt
  v_mfma_f32_16x16x32_bf16 v[16:19], v[128:131], v[12:15], 0
  v_mfma_f32_16x16x32_bf16 v[20:23], v[132:135], v[12:15], 0
  v_mfma_f32_16x16x32_bf16 v[24:27], v[136:139], v[12:15], 0
  v_mfma_f32_16x16x32_bf16 v[28:31], v[140:143], v[12:15], 0
  s_nop 4
  v_add_f32_dpp v48, v17, v16 row_ror:12 row_mask:0xf bank_mask:0x1
  v_add_f32_dpp v48, v18, v48 row_ror:8 row_mask:0xf bank_mask:0x1
  v_add_f32_dpp v48, v19, v48 row_ror:4 row_mask:0xf bank_mask:0x1
  v_add_f32_dpp v48, v22, v21 row_ror:12 row_mask:0xf bank_mask:0x2
  v_add_f32_dpp v48, v23, v48 row_ror:8 row_mask:0xf bank_mask:0x2
  v_add_f32_dpp v48, v20, v48 row_ror:4 row_mask:0xf bank_mask:0x2
  v_add_f32_dpp v48, v27, v26 row_ror:12 row_mask:0xf bank_mask:0x4
  v_add_f32_dpp v48, v24, v48 row_ror:8 row_mask:0xf bank_mask:0x4
  v_add_f32_dpp v48, v25, v48 row_ror:4 row_mask:0xf bank_mask:0x4
  v_add_f32_dpp v48, v28, v31 row_ror:12 row_mask:0xf bank_mask:0x8
  v_add_f32_dpp v48, v29, v48 row_ror:8 row_mask:0xf bank_mask:0x8
  v_add_f32_dpp v48, v30, v48 row_ror:4 row_mask:0xf bank_mask:0x8
  v_cvt_pk_bf16_f32 v48, 0, v48
  v_mul_f32 v48, s57, v48
  v_cvt_pk_bf16_f32 v48, 0, v48
  v_mul_f32 v49, s59, v48
  v_cmp_gt_f32 vcc, v49, v54
  s_cbranch_vccz L_nors2
  v_max_f32_dpp v49, v49, v49 row_ror:4 row_mask:0xf bank_mask:0xf
  s_nop 1
  v_max_f32_dpp v49, v49, v49 row_ror:8 row_mask:0xf bank_mask:0xf
  v_mov_b32 v50, v49
  s_nop 1
  v_permlane16_swap_b32 v49, v50
  v_max_f32 v49, v49, v50
  v_mov_b32 v50, v49
  s_nop 1
  v_permlane32_swap_b32 v49, v50
  v_max_f32 v49, v49, v50
  v_max_f32 v49, v49, v54
  v_sub_f32 v56, v54, v49
  v_exp_f32 v56, v56
  v_mov_b32 v54, v49
  v_mul_f32 v55, v55, v56
  v_mul_f32 v40, v40, v56
  v_mul_f32 v41, v41, v56
  v_mul_f32 v42, v42, v56
  v_mul_f32 v43, v43, v56
  v_mul_f32 v44, v44, v56
  v_mul_f32 v45, v45, v56
  v_mul_f32 v46, v46, v56
  v_mul_f32 v47, v47, v56
L_nors2:
  v_fma_f32 v48, v48, s59, -v54
  v_exp_f32 v48, v48
  s_nop 0
  v_cvt_pk_bf16_f32 v51, v48, 0
  v_cvt_pk_bf16_f32 v52, 0, v48
  v_add_f32 v55, v55, v48
  v_mov_b32_dpp v32, v51 quad_perm:[0,1,2,3] row_mask:0xf bank_mask:0x1
  v_mov_b32_dpp v32, v52 row_ror:4 row_mask:0xf bank_mask:0x2
  v_mov_b32_dpp v33, v51 row_ror:8 row_mask:0xf bank_mask:0x4
  v_mov_b32_dpp v33, v52 row_ror:12 row_mask:0xf bank_mask:0x8
  v_mov_b32_dpp v34, v51 row_ror:12 row_mask:0xf bank_mask:0x1
  v_mov_b32_dpp v34, v52 quad_perm:[0,1,2,3] row_mask:0xf bank_mask:0x2
  v_mov_b32_dpp v35, v51 row_ror:4 row_mask:0xf bank_mask:0x4
  v_mov_b32_dpp v35, v52 row_ror:8 row_mask:0xf bank_mask:0x8
  v_mfma_f32_16x16x16_bf16 v[40:43], v[144:145], v[32:33], v[40:43]
  v_mfma_f32_16x16x16_bf16 v[44:47], v[146:147], v[32:33], v[44:47]
  v_mov_b32_dpp v36, v51 row_ror:8 row_mask:0xf bank_mask:0x1
  v_mov_b32_dpp v36, v52 row_ror:12 row_mask:0xf bank_mask:0x2
  v_mov_b32_dpp v37, v51 quad_perm:[0,1,2,3] row_mask:0xf bank_mask:0x4
  v_mov_b32_dpp v37, v52 row_ror:4 row_mask:0xf bank_mask:0x8
  v_mfma_f32_16x16x16_bf16 v[40:43], v[148:149], v[34:35], v[40:43]
  v_mfma_f32_16x16x16_bf16 v[44:47], v[150:151], v[34:35], v[44:47]
  v_mov_b32_dpp v38, v51 row_ror:4 row_mask:0xf bank_mask:0x1
  v_mov_b32_dpp v38, v52 row_ror:8 row_mask:0xf bank_mask:0x2
  v_mov_b32_dpp v39, v51 row_ror:12 row_mask:0xf bank_mask:0x4
  v_mov_b32_dpp v39, v52 quad_perm:[0,1,2,3] row_mask:0xf bank_mask:0x8
  v_mfma_f32_16x16x16_bf16 v[40:43], v[152:153], v[36:37], v[40:43]
  v_mfma_f32_16x16x16_bf16 v[44:47], v[154:155], v[36:37], v[44:47]
  v_mfma_f32_16x16x16_bf16 v[40:43], v[156:157], v[38:39], v[40:43]
  v_mfma_f32_16x16x16_bf16 v[44:47], v[158:159], v[38:39], v[44:47]
  ds_read_b128 v[128:131], v6 offset:0
  ds_read_b128 v[132:135], v6 offset:1024
  ds_read_b128 v[136:139], v6 offset:2048
  ds_read_b128 v[140:143], v6 offset:3072
  ds_read_b128 v[144:147], v6 offset:4096
  ds_read_b128 v[148:151], v6 offset:5120
  ds_read_b128 v[152:155], v6 offset:6144
  ds_read_b128 v[156:159], v6 offset:7168
  v_mfma_f32_16x16x32_bf16 v[16:19], v[160:163], v[12:15], 0
  v_mfma_f32_16x16x32_bf16 v[20:23], v[164:167], v[12:15], 0
  v_mfma_f32_16x16x32_bf16 v[24:27], v[168:171], v[12:15], 0
  v_mfma_f32_16x16x32_bf16 v[28:31], v[172:175], v[12:15], 0
  s_nop 4
  v_add_f32_dpp v48, v17, v16 row_ror:12 row_mask:0xf bank_mask:0x1
  v_add_f32_dpp v48, v18, v48 row_ror:8 row_mask:0xf bank_mask:0x1
  v_add_f32_dpp v48, v19, v48 row_ror:4 row_mask:0xf bank_mask:0x1
  v_add_f32_dpp v48, v22, v21 row_ror:12 row_mask:0xf bank_mask:0x2
  v_add_f32_dpp v48, v23, v48 row_ror:8 row_mask:0xf bank_mask:0x2
  v_add_f32_dpp v48, v20, v48 row_ror:4 row_mask:0xf bank_mask:0x2
  v_add_f32_dpp v48, v27, v26 row_ror:12 row_mask:0xf bank_mask:0x4
  v_add_f32_dpp v48, v24, v48 row_ror:8 row_mask:0xf bank_mask:0x4
  v_add_f32_dpp v48, v25, v48 row_ror:4 row_mask:0xf bank_mask:0x4
  v_add_f32_dpp v48, v28, v31 row_ror:12 row_mask:0xf bank_mask:0x8
  v_add_f32_dpp v48, v29, v48 row_ror:8 row_mask:0xf bank_mask:0x8
  v_add_f32_dpp v48, v30, v48 row_ror:4 row_mask:0xf bank_mask:0x8
  v_cvt_pk_bf16_f32 v48, 0, v48
  v_mul_f32 v48, s57, v48
  v_cvt_pk_bf16_f32 v48, 0, v48
  v_mul_f32 v49, s59, v48
  v_cmp_gt_f32 vcc, v49, v54
  s_cbranch_vccz L_nors3
  v_max_f32_dpp v49, v49, v49 row_ror:4 row_mask:0xf bank_mask:0xf
  s_nop 1
  v_max_f32_dpp v49, v49, v49 row_ror:8 row_mask:0xf bank_mask:0xf
  v_mov_b32 v50, v49
  s_nop 1
  v_permlane16_swap_b32 v49, v50
  v_max_f32 v49, v49, v50
  v_mov_b32 v50, v49
  s_nop 1
  v_permlane32_swap_b32 v49, v50
  v_max_f32 v49, v49, v50
  v_max_f32 v49, v49, v54
  v_sub_f32 v56, v54, v49
  v_exp_f32 v56, v56
  v_mov_b32 v54, v49
  v_mul_f32 v55, v55, v56
  v_mul_f32 v40, v40, v56
  v_mul_f32 v41, v41, v56
  v_mul_f32 v42, v42, v56
  v_mul_f32 v43, v43, v56
  v_mul_f32 v44, v44, v56
  v_mul_f32 v45, v45, v56
  v_mul_f32 v46, v46, v56
  v_mul_f32 v47, v47, v56
L_nors3:
  v_fma_f32 v48, v48, s59, -v54
  v_exp_f32 v48, v48
  s_nop 0
  v_cvt_pk_bf16_f32 v51, v48, 0
  v_cvt_pk_bf16_f32 v52, 0, v48
  v_add_f32 v55, v55, v48
  v_mov_b32_dpp v32, v51 quad_perm:[0,1,2,3] row_mask:0xf bank_mask:0x1
  v_mov_b32_dpp v32, v52 row_ror:4 row_mask:0xf bank_mask:0x2
  v_mov_b32_dpp v33, v51 row_ror:8 row_mask:0xf bank_mask:0x4
  v_mov_b32_dpp v33, v52 row_ror:12 row_mask:0xf bank_mask:0x8
  v_mov_b32_dpp v34, v51 row_ror:12 row_mask:0xf bank_mask:0x1
  v_mov_b32_dpp v34, v52 quad_perm:[0,1,2,3] row_mask:0xf bank_mask:0x2
  v_mov_b32_dpp v35, v51 row_ror:4 row_mask:0xf bank_mask:0x4
  v_mov_b32_dpp v35, v52 row_ror:8 row_mask:0xf bank_mask:0x8
  v_mfma_f32_16x16x16_bf16 v[40:43], v[176:177], v[32:33], v[40:43]
  v_mfma_f32_16x16x16_bf16 v[44:47], v[178:179], v[32:33], v[44:47]
  v_mov_b32_dpp v36, v51 row_ror:8 row_mask:0xf bank_mask:0x1
  v_mov_b32_dpp v36, v52 row_ror:12 row_mask:0xf bank_mask:0x2
  v_mov_b32_dpp v37, v51 quad_perm:[0,1,2,3] row_mask:0xf bank_mask:0x4
  v_mov_b32_dpp v37, v52 row_ror:4 row_mask:0xf bank_mask:0x8
  v_mfma_f32_16x16x16_bf16 v[40:43], v[180:181], v[34:35], v[40:43]
  v_mfma_f32_16x16x16_bf16 v[44:47], v[182:183], v[34:35], v[44:47]
  v_mov_b32_dpp v38, v51 row_ror:4 row_mask:0xf bank_mask:0x1
  v_mov_b32_dpp v38, v52 row_ror:8 row_mask:0xf bank_mask:0x2
  v_mov_b32_dpp v39, v51 row_ror:12 row_mask:0xf bank_mask:0x4
  v_mov_b32_dpp v39, v52 quad_perm:[0,1,2,3] row_mask:0xf bank_mask:0x8
  v_mfma_f32_16x16x16_bf16 v[40:43], v[184:185], v[36:37], v[40:43]
  v_mfma_f32_16x16x16_bf16 v[44:47], v[186:187], v[36:37], v[44:47]
  v_mfma_f32_16x16x16_bf16 v[40:43], v[188:189], v[38:39], v[40:43]
  v_mfma_f32_16x16x16_bf16 v[44:47], v[190:191], v[38:39], v[44:47]
  v_mfma_f32_16x16x32_bf16 v[16:19], v[192:195], v[12:15], 0
  v_mfma_f32_16x16x32_bf16 v[20:23], v[196:199], v[12:15], 0
  v_mfma_f32_16x16x32_bf16 v[24:27], v[200:203], v[12:15], 0
  v_mfma_f32_16x16x32_bf16 v[28:31], v[204:207], v[12:15], 0
  s_nop 4
  v_add_f32_dpp v48, v17, v16 row_ror:12 row_mask:0xf bank_mask:0x1
  v_add_f32_dpp v48, v18, v48 row_ror:8 row_mask:0xf bank_mask:0x1
  v_add_f32_dpp v48, v19, v48 row_ror:4 row_mask:0xf bank_mask:0x1
  v_add_f32_dpp v48, v22, v21 row_ror:12 row_mask:0xf bank_mask:0x2
  v_add_f32_dpp v48, v23, v48 row_ror:8 row_mask:0xf bank_mask:0x2
  v_add_f32_dpp v48, v20, v48 row_ror:4 row_mask:0xf bank_mask:0x2
  v_add_f32_dpp v48, v27, v26 row_ror:12 row_mask:0xf bank_mask:0x4
  v_add_f32_dpp v48, v24, v48 row_ror:8 row_mask:0xf bank_mask:0x4
  v_add_f32_dpp v48, v25, v48 row_ror:4 row_mask:0xf bank_mask:0x4
  v_add_f32_dpp v48, v28, v31 row_ror:12 row_mask:0xf bank_mask:0x8
  v_add_f32_dpp v48, v29, v48 row_ror:8 row_mask:0xf bank_mask:0x8
  v_add_f32_dpp v48, v30, v48 row_ror:4 row_mask:0xf bank_mask:0x8
  v_cvt_pk_bf16_f32 v48, 0, v48
  v_mul_f32 v48, s57, v48
  v_cvt_pk_bf16_f32 v48, 0, v48
  v_mul_f32 v49, s59, v48
  v_cmp_gt_f32 vcc, v49, v54
  s_cbranch_vccz L_nors4
  v_max_f32_dpp v49, v49, v49 row_ror:4 row_mask:0xf bank_mask:0xf
  s_nop 1
  v_max_f32_dpp v49, v49, v49 row_ror:8 row_mask:0xf bank_mask:0xf
  v_mov_b32 v50, v49
  s_nop 1
  v_permlane16_swap_b32 v49, v50
  v_max_f32 v49, v49, v50
  v_mov_b32 v50, v49
  s_nop 1
  v_permlane32_swap_b32 v49, v50
  v_max_f32 v49, v49, v50
  v_max_f32 v49, v49, v54
  v_sub_f32 v56, v54, v49
  v_exp_f32 v56, v56
  v_mov_b32 v54, v49
  v_mul_f32 v55, v55, v56
  v_mul_f32 v40, v40, v56
  v_mul_f32 v41, v41, v56
  v_mul_f32 v42, v42, v56
  v_mul_f32 v43, v43, v56
  v_mul_f32 v44, v44, v56
  v_mul_f32 v45, v45, v56
  v_mul_f32 v46, v46, v56
  v_mul_f32 v47, v47, v56
L_nors4:
  v_fma_f32 v48, v48, s59, -v54
  v_exp_f32 v48, v48
  s_nop 0
  v_cvt_pk_bf16_f32 v51, v48, 0
  v_cvt_pk_bf16_f32 v52, 0, v48
  v_add_f32 v55, v55, v48
  v_mov_b32_dpp v32, v51 quad_perm:[0,1,2,3] row_mask:0xf bank_mask:0x1
  v_mov_b32_dpp v32, v52 row_ror:4 row_mask:0xf bank_mask:0x2
  v_mov_b32_dpp v33, v51 row_ror:8 row_mask:0xf bank_mask:0x4
  v_mov_b32_dpp v33, v52 row_ror:12 row_mask:0xf bank_mask:0x8
  v_mov_b32_dpp v34, v51 row_ror:12 row_mask:0xf bank_mask:0x1
  v_mov_b32_dpp v34, v52 quad_perm:[0,1,2,3] row_mask:0xf bank_mask:0x2
  v_mov_b32_dpp v35, v51 row_ror:4 row_mask:0xf bank_mask:0x4
  v_mov_b32_dpp v35, v52 row_ror:8 row_mask:0xf bank_mask:0x8
  v_mfma_f32_16x16x16_bf16 v[40:43], v[208:209], v[32:33], v[40:43]
  v_mfma_f32_16x16x16_bf16 v[44:47], v[210:211], v[32:33], v[44:47]
  v_mov_b32_dpp v36, v51 row_ror:8 row_mask:0xf bank_mask:0x1
  v_mov_b32_dpp v36, v52 row_ror:12 row_mask:0xf bank_mask:0x2
  v_mov_b32_dpp v37, v51 quad_perm:[0,1,2,3] row_mask:0xf bank_mask:0x4
  v_mov_b32_dpp v37, v52 row_ror:4 row_mask:0xf bank_mask:0x8
  v_mfma_f32_16x16x16_bf16 v[40:43], v[212:213], v[34:35], v[40:43]
  v_mfma_f32_16x16x16_bf16 v[44:47], v[214:215], v[34:35], v[44:47]
  v_mov_b32_dpp v38, v51 row_ror:4 row_mask:0xf bank_mask:0x1
  v_mov_b32_dpp v38, v52 row_ror:8 row_mask:0xf bank_mask:0x2
  v_mov_b32_dpp v39, v51 row_ror:12 row_mask:0xf bank_mask:0x4
  v_mov_b32_dpp v39, v52 quad_perm:[0,1,2,3] row_mask:0xf bank_mask:0x8
  v_mfma_f32_16x16x16_bf16 v[40:43], v[216:217], v[36:37], v[40:43]
  v_mfma_f32_16x16x16_bf16 v[44:47], v[218:219], v[36:37], v[44:47]
  v_mfma_f32_16x16x16_bf16 v[40:43], v[220:221], v[38:39], v[40:43]
  v_mfma_f32_16x16x16_bf16 v[44:47], v[222:223], v[38:39], v[44:47]
  v_mfma_f32_16x16x32_bf16 v[16:19], v[224:227], v[12:15], 0
  v_mfma_f32_16x16x32_bf16 v[20:23], v[228:231], v[12:15], 0
  v_mfma_f32_16x16x32_bf16 v[24:27], v[232:235], v[12:15], 0
  v_mfma_f32_16x16x32_bf16 v[28:31], v[236:239], v[12:15], 0
  s_nop 4
  v_add_f32_dpp v48, v17, v16 row_ror:12 row_mask:0xf bank_mask:0x1
  v_add_f32_dpp v48, v18, v48 row_ror:8 row_mask:0xf bank_mask:0x1
  v_add_f32_dpp v48, v19, v48 row_ror:4 row_mask:0xf bank_mask:0x1
  v_add_f32_dpp v48, v22, v21 row_ror:12 row_mask:0xf bank_mask:0x2
  v_add_f32_dpp v48, v23, v48 row_ror:8 row_mask:0xf bank_mask:0x2
  v_add_f32_dpp v48, v20, v48 row_ror:4 row_mask:0xf bank_mask:0x2
  v_add_f32_dpp v48, v27, v26 row_ror:12 row_mask:0xf bank_mask:0x4
  v_add_f32_dpp v48, v24, v48 row_ror:8 row_mask:0xf bank_mask:0x4
  v_add_f32_dpp v48, v25, v48 row_ror:4 row_mask:0xf bank_mask:0x4
  v_add_f32_dpp v48, v28, v31 row_ror:12 row_mask:0xf bank_mask:0x8
  v_add_f32_dpp v48, v29, v48 row_ror:8 row_mask:0xf bank_mask:0x8
  v_add_f32_dpp v48, v30, v48 row_ror:4 row_mask:0xf bank_mask:0x8
  v_cvt_pk_bf16_f32 v48, 0, v48
  v_mul_f32 v48, s57, v48
  v_cvt_pk_bf16_f32 v48, 0, v48
  v_mul_f32 v49, s59, v48
  v_cmp_gt_f32 vcc, v49, v54
  s_cbranch_vccz L_nors5
  v_max_f32_dpp v49, v49, v49 row_ror:4 row_mask:0xf bank_mask:0xf
  s_nop 1
  v_max_f32_dpp v49, v49, v49 row_ror:8 row_mask:0xf bank_mask:0xf
  v_mov_b32 v50, v49
  s_nop 1
  v_permlane16_swap_b32 v49, v50
  v_max_f32 v49, v49, v50
  v_mov_b32 v50, v49
  s_nop 1
  v_permlane32_swap_b32 v49, v50
  v_max_f32 v49, v49, v50
  v_max_f32 v49, v49, v54
  v_sub_f32 v56, v54, v49
  v_exp_f32 v56, v56
  v_mov_b32 v54, v49
  v_mul_f32 v55, v55, v56
  v_mul_f32 v40, v40, v56
  v_mul_f32 v41, v41, v56
  v_mul_f32 v42, v42, v56
  v_mul_f32 v43, v43, v56
  v_mul_f32 v44, v44, v56
  v_mul_f32 v45, v45, v56
  v_mul_f32 v46, v46, v56
  v_mul_f32 v47, v47, v56
L_nors5:
  v_fma_f32 v48, v48, s59, -v54
  v_exp_f32 v48, v48
  s_nop 0
  v_cvt_pk_bf16_f32 v51, v48, 0
  v_cvt_pk_bf16_f32 v52, 0, v48
  v_add_f32 v55, v55, v48
  v_mov_b32_dpp v32, v51 quad_perm:[0,1,2,3] row_mask:0xf bank_mask:0x1
  v_mov_b32_dpp v32, v52 row_ror:4 row_mask:0xf bank_mask:0x2
  v_mov_b32_dpp v33, v51 row_ror:8 row_mask:0xf bank_mask:0x4
  v_mov_b32_dpp v33, v52 row_ror:12 row_mask:0xf bank_mask:0x8
  v_mov_b32_dpp v34, v51 row_ror:12 row_mask:0xf bank_mask:0x1
  v_mov_b32_dpp v34, v52 quad_perm:[0,1,2,3] row_mask:0xf bank_mask:0x2
  v_mov_b32_dpp v35, v51 row_ror:4 row_mask:0xf bank_mask:0x4
  v_mov_b32_dpp v35, v52 row_ror:8 row_mask:0xf bank_mask:0x8
  v_mfma_f32_16x16x16_bf16 v[40:43], v[240:241], v[32:33], v[40:43]
  v_mfma_f32_16x16x16_bf16 v[44:47], v[242:243], v[32:33], v[44:47]
  v_mov_b32_dpp v36, v51 row_ror:8 row_mask:0xf bank_mask:0x1
  v_mov_b32_dpp v36, v52 row_ror:12 row_mask:0xf bank_mask:0x2
  v_mov_b32_dpp v37, v51 quad_perm:[0,1,2,3] row_mask:0xf bank_mask:0x4
  v_mov_b32_dpp v37, v52 row_ror:4 row_mask:0xf bank_mask:0x8
  v_mfma_f32_16x16x16_bf16 v[40:43], v[244:245], v[34:35], v[40:43]
  v_mfma_f32_16x16x16_bf16 v[44:47], v[246:247], v[34:35], v[44:47]
  v_mov_b32_dpp v38, v51 row_ror:4 row_mask:0xf bank_mask:0x1
  v_mov_b32_dpp v38, v52 row_ror:8 row_mask:0xf bank_mask:0x2
  v_mov_b32_dpp v39, v51 row_ror:12 row_mask:0xf bank_mask:0x4
  v_mov_b32_dpp v39, v52 quad_perm:[0,1,2,3] row_mask:0xf bank_mask:0x8
  v_mfma_f32_16x16x16_bf16 v[40:43], v[248:249], v[36:37], v[40:43]
  v_mfma_f32_16x16x16_bf16 v[44:47], v[250:251], v[36:37], v[44:47]
  v_mfma_f32_16x16x16_bf16 v[40:43], v[252:253], v[38:39], v[40:43]
  v_mfma_f32_16x16x16_bf16 v[44:47], v[254:255], v[38:39], v[44:47]
  s_waitcnt lgkmcnt(0)
  v_mfma_f32_16x16x32_bf16 v[16:19], v[128:131], v[12:15], 0
  v_mfma_f32_16x16x32_bf16 v[20:23], v[132:135], v[12:15], 0
  v_mfma_f32_16x16x32_bf16 v[24:27], v[136:139], v[12:15], 0
  v_mfma_f32_16x16x32_bf16 v[28:31], v[140:143], v[12:15], 0
  s_nop 4
  v_add_f32_dpp v48, v17, v16 row_ror:12 row_mask:0xf bank_mask:0x1
  v_add_f32_dpp v48, v18, v48 row_ror:8 row_mask:0xf bank_mask:0x1
  v_add_f32_dpp v48, v19, v48 row_ror:4 row_mask:0xf bank_mask:0x1
  v_add_f32_dpp v48, v22, v21 row_ror:12 row_mask:0xf bank_mask:0x2
  v_add_f32_dpp v48, v23, v48 row_ror:8 row_mask:0xf bank_mask:0x2
  v_add_f32_dpp v48, v20, v48 row_ror:4 row_mask:0xf bank_mask:0x2
  v_add_f32_dpp v48, v27, v26 row_ror:12 row_mask:0xf bank_mask:0x4
  v_add_f32_dpp v48, v24, v48 row_ror:8 row_mask:0xf bank_mask:0x4
  v_add_f32_dpp v48, v25, v48 row_ror:4 row_mask:0xf bank_mask:0x4
  v_add_f32_dpp v48, v28, v31 row_ror:12 row_mask:0xf bank_mask:0x8
  v_add_f32_dpp v48, v29, v48 row_ror:8 row_mask:0xf bank_mask:0x8
  v_add_f32_dpp v48, v30, v48 row_ror:4 row_mask:0xf bank_mask:0x8
  v_cvt_pk_bf16_f32 v48, 0, v48
  v_mul_f32 v48, s57, v48
  v_cvt_pk_bf16_f32 v48, 0, v48
  v_mul_f32 v49, s59, v48
  v_cmp_gt_f32 vcc, v49, v54
  s_cbranch_vccz L_nors6
  v_max_f32_dpp v49, v49, v49 row_ror:4 row_mask:0xf bank_mask:0xf
  s_nop 1
  v_max_f32_dpp v49, v49, v49 row_ror:8 row_mask:0xf bank_mask:0xf
  v_mov_b32 v50, v49
  s_nop 1
  v_permlane16_swap_b32 v49, v50
  v_max_f32 v49, v49, v50
  v_mov_b32 v50, v49
  s_nop 1
  v_permlane32_swap_b32 v49, v50
  v_max_f32 v49, v49, v50
  v_max_f32 v49, v49, v54
  v_sub_f32 v56, v54, v49
  v_exp_f32 v56, v56
  v_mov_b32 v54, v49
  v_mul_f32 v55, v55, v56
  v_mul_f32 v40, v40, v56
  v_mul_f32 v41, v41, v56
  v_mul_f32 v42, v42, v56
  v_mul_f32 v43, v43, v56
  v_mul_f32 v44, v44, v56
  v_mul_f32 v45, v45, v56
  v_mul_f32 v46, v46, v56
  v_mul_f32 v47, v47, v56
L_nors6:
  v_fma_f32 v48, v48, s59, -v54
  v_exp_f32 v48, v48
  s_nop 0
  v_cvt_pk_bf16_f32 v51, v48, 0
  v_cvt_pk_bf16_f32 v52, 0, v48
  v_add_f32 v55, v55, v48
  v_mov_b32_dpp v32, v51 quad_perm:[0,1,2,3] row_mask:0xf bank_mask:0x1
  v_mov_b32_dpp v32, v52 row_ror:4 row_mask:0xf bank_mask:0x2
  v_mov_b32_dpp v33, v51 row_ror:8 row_mask:0xf bank_mask:0x4
  v_mov_b32_dpp v33, v52 row_ror:12 row_mask:0xf bank_mask:0x8
  v_mov_b32_dpp v34, v51 row_ror:12 row_mask:0xf bank_mask:0x1
  v_mov_b32_dpp v34, v52 quad_perm:[0,1,2,3] row_mask:0xf bank_mask:0x2
  v_mov_b32_dpp v35, v51 row_ror:4 row_mask:0xf bank_mask:0x4
  v_mov_b32_dpp v35, v52 row_ror:8 row_mask:0xf bank_mask:0x8
  v_mfma_f32_16x16x16_bf16 v[40:43], v[144:145], v[32:33], v[40:43]
  v_mfma_f32_16x16x16_bf16 v[44:47], v[146:147], v[32:33], v[44:47]
  v_mov_b32_dpp v36, v51 row_ror:8 row_mask:0xf bank_mask:0x1
  v_mov_b32_dpp v36, v52 row_ror:12 row_mask:0xf bank_mask:0x2
  v_mov_b32_dpp v37, v51 quad_perm:[0,1,2,3] row_mask:0xf bank_mask:0x4
  v_mov_b32_dpp v37, v52 row_ror:4 row_mask:0xf bank_mask:0x8
  v_mfma_f32_16x16x16_bf16 v[40:43], v[148:149], v[34:35], v[40:43]
  v_mfma_f32_16x16x16_bf16 v[44:47], v[150:151], v[34:35], v[44:47]
  v_mov_b32_dpp v38, v51 row_ror:4 row_mask:0xf bank_mask:0x1
  v_mov_b32_dpp v38, v52 row_ror:8 row_mask:0xf bank_mask:0x2
  v_mov_b32_dpp v39, v51 row_ror:12 row_mask:0xf bank_mask:0x4
  v_mov_b32_dpp v39, v52 quad_perm:[0,1,2,3] row_mask:0xf bank_mask:0x8
  v_mfma_f32_16x16x16_bf16 v[40:43], v[152:153], v[36:37], v[40:43]
  v_mfma_f32_16x16x16_bf16 v[44:47], v[154:155], v[36:37], v[44:47]
  v_mfma_f32_16x16x16_bf16 v[40:43], v[156:157], v[38:39], v[40:43]
  v_mfma_f32_16x16x16_bf16 v[44:47], v[158:159], v[38:39], v[44:47]
  s_waitcnt vmcnt(16)
  ds_read_b128 v[160:163], v6 offset:8192
  ds_read_b128 v[164:167], v6 offset:9216
  ds_read_b128 v[168:171], v6 offset:10240
  ds_read_b128 v[172:175], v6 offset:11264
  ds_read_b128 v[176:179], v6 offset:12288
  ds_read_b128 v[180:183], v6 offset:13312
  ds_read_b128 v[184:187], v6 offset:14336
  ds_read_b128 v[188:191], v6 offset:15360
  s_waitcnt lgkmcnt(0)
  v_mfma_f32_16x16x32_bf16 v[16:19], v[160:163], v[12:15], 0
  v_mfma_f32_16x16x32_bf16 v[20:23], v[164:167], v[12:15], 0
  v_mfma_f32_16x16x32_bf16 v[24:27], v[168:171], v[12:15], 0
  v_mfma_f32_16x16x32_bf16 v[28:31], v[172:175], v[12:15], 0
  s_nop 4
  v_add_f32_dpp v48, v17, v16 row_ror:12 row_mask:0xf bank_mask:0x1
  v_add_f32_dpp v48, v18, v48 row_ror:8 row_mask:0xf bank_mask:0x1
  v_add_f32_dpp v48, v19, v48 row_ror:4 row_mask:0xf bank_mask:0x1
  v_add_f32_dpp v48, v22, v21 row_ror:12 row_mask:0xf bank_mask:0x2
  v_add_f32_dpp v48, v23, v48 row_ror:8 row_mask:0xf bank_mask:0x2
  v_add_f32_dpp v48, v20, v48 row_ror:4 row_mask:0xf bank_mask:0x2
  v_add_f32_dpp v48, v27, v26 row_ror:12 row_mask:0xf bank_mask:0x4
  v_add_f32_dpp v48, v24, v48 row_ror:8 row_mask:0xf bank_mask:0x4
  v_add_f32_dpp v48, v25, v48 row_ror:4 row_mask:0xf bank_mask:0x4
  v_add_f32_dpp v48, v28, v31 row_ror:12 row_mask:0xf bank_mask:0x8
  v_add_f32_dpp v48, v29, v48 row_ror:8 row_mask:0xf bank_mask:0x8
  v_add_f32_dpp v48, v30, v48 row_ror:4 row_mask:0xf bank_mask:0x8
  v_cvt_pk_bf16_f32 v48, 0, v48
  v_mul_f32 v48, s57, v48
  v_cvt_pk_bf16_f32 v48, 0, v48
  v_mul_f32 v49, s59, v48
  v_cmp_gt_f32 vcc, v49, v54
  s_cbranch_vccz L_nors7
  v_max_f32_dpp v49, v49, v49 row_ror:4 row_mask:0xf bank_mask:0xf
  s_nop 1
  v_max_f32_dpp v49, v49, v49 row_ror:8 row_mask:0xf bank_mask:0xf
  v_mov_b32 v50, v49
  s_nop 1
  v_permlane16_swap_b32 v49, v50
  v_max_f32 v49, v49, v50
  v_mov_b32 v50, v49
  s_nop 1
  v_permlane32_swap_b32 v49, v50
  v_max_f32 v49, v49, v50
  v_max_f32 v49, v49, v54
  v_sub_f32 v56, v54, v49
  v_exp_f32 v56, v56
  v_mov_b32 v54, v49
  v_mul_f32 v55, v55, v56
  v_mul_f32 v40, v40, v56
  v_mul_f32 v41, v41, v56
  v_mul_f32 v42, v42, v56
  v_mul_f32 v43, v43, v56
  v_mul_f32 v44, v44, v56
  v_mul_f32 v45, v45, v56
  v_mul_f32 v46, v46, v56
  v_mul_f32 v47, v47, v56
L_nors7:
  v_fma_f32 v48, v48, s59, -v54
  v_exp_f32 v48, v48
  s_nop 0
  v_cvt_pk_bf16_f32 v51, v48, 0
  v_cvt_pk_bf16_f32 v52, 0, v48
  v_add_f32 v55, v55, v48
  v_mov_b32_dpp v32, v51 quad_perm:[0,1,2,3] row_mask:0xf bank_mask:0x1
  v_mov_b32_dpp v32, v52 row_ror:4 row_mask:0xf bank_mask:0x2
  v_mov_b32_dpp v33, v51 row_ror:8 row_mask:0xf bank_mask:0x4
  v_mov_b32_dpp v33, v52 row_ror:12 row_mask:0xf bank_mask:0x8
  v_mov_b32_dpp v34, v51 row_ror:12 row_mask:0xf bank_mask:0x1
  v_mov_b32_dpp v34, v52 quad_perm:[0,1,2,3] row_mask:0xf bank_mask:0x2
  v_mov_b32_dpp v35, v51 row_ror:4 row_mask:0xf bank_mask:0x4
  v_mov_b32_dpp v35, v52 row_ror:8 row_mask:0xf bank_mask:0x8
  v_mfma_f32_16x16x16_bf16 v[40:43], v[176:177], v[32:33], v[40:43]
  v_mfma_f32_16x16x16_bf16 v[44:47], v[178:179], v[32:33], v[44:47]
  v_mov_b32_dpp v36, v51 row_ror:8 row_mask:0xf bank_mask:0x1
  v_mov_b32_dpp v36, v52 row_ror:12 row_mask:0xf bank_mask:0x2
  v_mov_b32_dpp v37, v51 quad_perm:[0,1,2,3] row_mask:0xf bank_mask:0x4
  v_mov_b32_dpp v37, v52 row_ror:4 row_mask:0xf bank_mask:0x8
  v_mfma_f32_16x16x16_bf16 v[40:43], v[180:181], v[34:35], v[40:43]
  v_mfma_f32_16x16x16_bf16 v[44:47], v[182:183], v[34:35], v[44:47]
  v_mov_b32_dpp v38, v51 row_ror:4 row_mask:0xf bank_mask:0x1
  v_mov_b32_dpp v38, v52 row_ror:8 row_mask:0xf bank_mask:0x2
  v_mov_b32_dpp v39, v51 row_ror:12 row_mask:0xf bank_mask:0x4
  v_mov_b32_dpp v39, v52 quad_perm:[0,1,2,3] row_mask:0xf bank_mask:0x8
  v_mfma_f32_16x16x16_bf16 v[40:43], v[184:185], v[36:37], v[40:43]
  v_mfma_f32_16x16x16_bf16 v[44:47], v[186:187], v[36:37], v[44:47]
  v_mfma_f32_16x16x16_bf16 v[40:43], v[188:189], v[38:39], v[40:43]
  v_mfma_f32_16x16x16_bf16 v[44:47], v[190:191], v[38:39], v[44:47]
  s_mov_b32 s60, 9
  s_mul_i32 s58, s43, 1
  s_sub_u32 s60, s60, s58
  s_add_u32 s63, s63, 1220
L_pace:
  s_memrealtime s[64:65]
  s_waitcnt lgkmcnt(0)
  s_sub_u32 s64, s64, s63
  s_add_u32 s63, s63, 226
  s_cmp_lt_i32 s64, -40
  s_cbranch_scc1 L_p0
  s_cmp_lt_i32 s64, 30
  s_cbranch_scc1 L_p1
  s_cmp_lt_i32 s64, 120
  s_cbranch_scc1 L_p2
  s_cmp_lt_i32 s64, 240
  s_cbranch_scc1 L_p3
L_p4:
  s_add_u32 s48, s48, 65536
  s_waitcnt vmcnt(12)
  v_mfma_f32_16x16x32_bf16 v[16:19], v[64:67], v[12:15], 0
  buffer_load_dwordx4 v[64:67], v1, s[32:35], s48 offen offset:0 nt
  s_waitcnt vmcnt(12)
  v_mfma_f32_16x16x32_bf16 v[20:23], v[68:71], v[12:15], 0
  buffer_load_dwordx4 v[68:71], v1, s[32:35], s48 offen offset:1024 nt
  s_waitcnt vmcnt(12)
  v_mfma_f32_16x16x32_bf16 v[24:27], v[72:75], v[12:15], 0
  buffer_load_dwordx4 v[72:75], v1, s[32:35], s48 offen offset:2048 nt
  s_waitcnt vmcnt(12)
  v_mfma_f32_16x16x32_bf16 v[28:31], v[76:79], v[12:15], 0
  buffer_load_dwordx4 v[76:79], v1, s[32:35], s48 offen offset:3072 nt
  s_nop 4
  v_add_f32_dpp v48, v17, v16 row_ror:12 row_mask:0xf bank_mask:0x1
  v_add_f32_dpp v48, v18, v48 row_ror:8 row_mask:0xf bank_mask:0x1
  v_add_f32_dpp v48, v19, v48 row_ror:4 row_mask:0xf bank_mask:0x1
  v_add_f32_dpp v48, v22, v21 row_ror:12 row_mask:0xf bank_mask:0x2
  v_add_f32_dpp v48, v23, v48 row_ror:8 row_mask:0xf bank_mask:0x2
  v_add_f32_dpp v48, v20, v48 row_ror:4 row_mask:0xf bank_mask:0x2
  v_add_f32_dpp v48, v27, v26 row_ror:12 row_mask:0xf bank_mask:0x4
  v_add_f32_dpp v48, v24, v48 row_ror:8 row_mask:0xf bank_mask:0x4
  v_add_f32_dpp v48, v25, v48 row_ror:4 row_mask:0xf bank_mask:0x4
  v_add_f32_dpp v48, v28, v31 row_ror:12 row_mask:0xf bank_mask:0x8
  v_add_f32_dpp v48, v29, v48 row_ror:8 row_mask:0xf bank_mask:0x8
  v_add_f32_dpp v48, v30, v48 row_ror:4 row_mask:0xf bank_mask:0x8
  v_cvt_pk_bf16_f32 v48, 0, v48
  v_mul_f32 v48, s57, v48
  v_cvt_pk_bf16_f32 v48, 0, v48
  v_mul_f32 v49, s59, v48
  v_cmp_gt_f32 vcc, v49, v54
  s_cbranch_vccz L_nors8
  v_max_f32_dpp v49, v49, v49 row_ror:4 row_mask:0xf bank_mask:0xf
  s_nop 1
  v_max_f32_dpp v49, v49, v49 row_ror:8 row_mask:0xf bank_mask:0xf
  v_mov_b32 v50, v49
  s_nop 1
  v_permlane16_swap_b32 v49, v50
  v_max_f32 v49, v49, v50
  v_mov_b32 v50, v49
  s_nop 1
  v_permlane32_swap_b32 v49, v50
  v_max_f32 v49, v49, v50
  v_max_f32 v49, v49, v54
  v_sub_f32 v56, v54, v49
  v_exp_f32 v56, v56
  v_mov_b32 v54, v49
  v_mul_f32 v55, v55, v56
  v_mul_f32 v40, v40, v56
  v_mul_f32 v41, v41, v56
  v_mul_f32 v42, v42, v56
  v_mul_f32 v43, v43, v56
  v_mul_f32 v44, v44, v56
  v_mul_f32 v45, v45, v56
  v_mul_f32 v46, v46, v56
  v_mul_f32 v47, v47, v56
L_nors8:
  v_fma_f32 v48, v48, s59, -v54
  v_exp_f32 v48, v48
  s_nop 0
  v_cvt_pk_bf16_f32 v51, v48, 0
  v_cvt_pk_bf16_f32 v52, 0, v48
  v_add_f32 v55, v55, v48
  v_mov_b32_dpp v32, v51 quad_perm:[0,1,2,3] row_mask:0xf bank_mask:0x1
  v_mov_b32_dpp v32, v52 row_ror:4 row_mask:0xf bank_mask:0x2
  v_mov_b32_dpp v33, v51 row_ror:8 row_mask:0xf bank_mask:0x4
  v_mov_b32_dpp v33, v52 row_ror:12 row_mask:0xf bank_mask:0x8
  v_mov_b32_dpp v34, v51 row_ror:12 row_mask:0xf bank_mask:0x1
  v_mov_b32_dpp v34, v52 quad_perm:[0,1,2,3] row_mask:0xf bank_mask:0x2
  v_mov_b32_dpp v35, v51 row_ror:4 row_mask:0xf bank_mask:0x4
  v_mov_b32_dpp v35, v52 row_ror:8 row_mask:0xf bank_mask:0x8
  s_waitcnt vmcnt(12)
  v_mfma_f32_16x16x16_bf16 v[40:43], v[80:81], v[32:33], v[40:43]
  v_mfma_f32_16x16x16_bf16 v[44:47], v[82:83], v[32:33], v[44:47]
  buffer_load_dwordx4 v[80:83], v2, s[36:39], s48 offen offset:0 nt
  v_mov_b32_dpp v36, v51 row_ror:8 row_mask:0xf bank_mask:0x1
  v_mov_b32_dpp v36, v52 row_ror:12 row_mask:0xf bank_mask:0x2
  v_mov_b32_dpp v37, v51 quad_perm:[0,1,2,3] row_mask:0xf bank_mask:0x4
  v_mov_b32_dpp v37, v52 row_ror:4 row_mask:0xf bank_mask:0x8
  s_waitcnt vmcnt(12)
  v_mfma_f32_16x16x16_bf16 v[40:43], v[84:85], v[34:35], v[40:43]
  v_mfma_f32_16x16x16_bf16 v[44:47], v[86:87], v[34:35], v[44:47]
  buffer_load_dwordx4 v[84:87], v2, s[36:39], s48 offen offset:1024 nt
  v_mov_b32_dpp v38, v51 row_ror:4 row_mask:0xf bank_mask:0x1
  v_mov_b32_dpp v38, v52 row_ror:8 row_mask:0xf bank_mask:0x2
  v_mov_b32_dpp v39, v51 row_ror:12 row_mask:0xf bank_mask:0x4
  v_mov_b32_dpp v39, v52 quad_perm:[0,1,2,3] row_mask:0xf bank_mask:0x8
  s_waitcnt vmcnt(12)
  v_mfma_f32_16x16x16_bf16 v[40:43], v[88:89], v[36:37], v[40:43]
  v_mfma_f32_16x16x16_bf16 v[44:47], v[90:91], v[36:37], v[44:47]
  buffer_load_dwordx4 v[88:91], v2, s[36:39], s48 offen offset:2048 nt
  s_waitcnt vmcnt(12)
  v_mfma_f32_16x16x16_bf16 v[40:43], v[92:93], v[38:39], v[40:43]
  v_mfma_f32_16x16x16_bf16 v[44:47], v[94:95], v[38:39], v[44:47]
  buffer_load_dwordx4 v[92:95], v2, s[36:39], s48 offen offset:3072 nt
  s_add_u32 s48, s48, 65536
  s_waitcnt vmcnt(12)
  v_mfma_f32_16x16x32_bf16 v[16:19], v[96:99], v[12:15], 0
  buffer_load_dwordx4 v[96:99], v1, s[32:35], s48 offen offset:0 nt
  s_waitcnt vmcnt(12)
  v_mfma_f32_16x16x32_bf16 v[20:23], v[100:103], v[12:15], 0
  buffer_load_dwordx4 v[100:103], v1, s[32:35], s48 offen offset:1024 nt
  s_waitcnt vmcnt(12)
  v_mfma_f32_16x16x32_bf16 v[24:27], v[104:107], v[12:15], 0
  buffer_load_dwordx4 v[104:107], v1, s[32:35], s48 offen offset:2048 nt
  s_waitcnt vmcnt(12)
  v_mfma_f32_16x16x32_bf16 v[28:31], v[108:111], v[12:15], 0
  buffer_load_dwordx4 v[108:111], v1, s[32:35], s48 offen offset:3072 nt
  s_nop 4
  v_add_f32_dpp v48, v17, v16 row_ror:12 row_mask:0xf bank_mask:0x1
  v_add_f32_dpp v48, v18, v48 row_ror:8 row_mask:0xf bank_mask:0x1
  v_add_f32_dpp v48, v19, v48 row_ror:4 row_mask:0xf bank_mask:0x1
  v_add_f32_dpp v48, v22, v21 row_ror:12 row_mask:0xf bank_mask:0x2
  v_add_f32_dpp v48, v23, v48 row_ror:8 row_mask:0xf bank_mask:0x2
  v_add_f32_dpp v48, v20, v48 row_ror:4 row_mask:0xf bank_mask:0x2
  v_add_f32_dpp v48, v27, v26 row_ror:12 row_mask:0xf bank_mask:0x4
  v_add_f32_dpp v48, v24, v48 row_ror:8 row_mask:0xf bank_mask:0x4
  v_add_f32_dpp v48, v25, v48 row_ror:4 row_mask:0xf bank_mask:0x4
  v_add_f32_dpp v48, v28, v31 row_ror:12 row_mask:0xf bank_mask:0x8
  v_add_f32_dpp v48, v29, v48 row_ror:8 row_mask:0xf bank_mask:0x8
  v_add_f32_dpp v48, v30, v48 row_ror:4 row_mask:0xf bank_mask:0x8
  v_cvt_pk_bf16_f32 v48, 0, v48
  v_mul_f32 v48, s57, v48
  v_cvt_pk_bf16_f32 v48, 0, v48
  v_mul_f32 v49, s59, v48
  v_cmp_gt_f32 vcc, v49, v54
  s_cbranch_vccz L_nors9
  v_max_f32_dpp v49, v49, v49 row_ror:4 row_mask:0xf bank_mask:0xf
  s_nop 1
  v_max_f32_dpp v49, v49, v49 row_ror:8 row_mask:0xf bank_mask:0xf
  v_mov_b32 v50, v49
  s_nop 1
  v_permlane16_swap_b32 v49, v50
  v_max_f32 v49, v49, v50
  v_mov_b32 v50, v49
  s_nop 1
  v_permlane32_swap_b32 v49, v50
  v_max_f32 v49, v49, v50
  v_max_f32 v49, v49, v54
  v_sub_f32 v56, v54, v49
  v_exp_f32 v56, v56
  v_mov_b32 v54, v49
  v_mul_f32 v55, v55, v56
  v_mul_f32 v40, v40, v56
  v_mul_f32 v41, v41, v56
  v_mul_f32 v42, v42, v56
  v_mul_f32 v43, v43, v56
  v_mul_f32 v44, v44, v56
  v_mul_f32 v45, v45, v56
  v_mul_f32 v46, v46, v56
  v_mul_f32 v47, v47, v56
L_nors9:
  v_fma_f32 v48, v48, s59, -v54
  v_exp_f32 v48, v48
  s_nop 0
  v_cvt_pk_bf16_f32 v51, v48, 0
  v_cvt_pk_bf16_f32 v52, 0, v48
  v_add_f32 v55, v55, v48
  v_mov_b32_dpp v32, v51 quad_perm:[0,1,2,3] row_mask:0xf bank_mask:0x1
  v_mov_b32_dpp v32, v52 row_ror:4 row_mask:0xf bank_mask:0x2
  v_mov_b32_dpp v33, v51 row_ror:8 row_mask:0xf bank_mask:0x4
  v_mov_b32_dpp v33, v52 row_ror:12 row_mask:0xf bank_mask:0x8
  v_mov_b32_dpp v34, v51 row_ror:12 row_mask:0xf bank_mask:0x1
  v_mov_b32_dpp v34, v52 quad_perm:[0,1,2,3] row_mask:0xf bank_mask:0x2
  v_mov_b32_dpp v35, v51 row_ror:4 row_mask:0xf bank_mask:0x4
  v_mov_b32_dpp v35, v52 row_ror:8 row_mask:0xf bank_mask:0x8
  s_waitcnt vmcnt(12)
  v_mfma_f32_16x16x16_bf16 v[40:43], v[112:113], v[32:33], v[40:43]
  v_mfma_f32_16x16x16_bf16 v[44:47], v[114:115], v[32:33], v[44:47]
  buffer_load_dwordx4 v[112:115], v2, s[36:39], s48 offen offset:0 nt
  v_mov_b32_dpp v36, v51 row_ror:8 row_mask:0xf bank_mask:0x1
  v_mov_b32_dpp v36, v52 row_ror:12 row_mask:0xf bank_mask:0x2
  v_mov_b32_dpp v37, v51 quad_perm:[0,1,2,3] row_mask:0xf bank_mask:0x4
  v_mov_b32_dpp v37, v52 row_ror:4 row_mask:0xf bank_mask:0x8
  s_waitcnt vmcnt(12)
  v_mfma_f32_16x16x16_bf16 v[40:43], v[116:117], v[34:35], v[40:43]
  v_mfma_f32_16x16x16_bf16 v[44:47], v[118:119], v[34:35], v[44:47]
  buffer_load_dwordx4 v[116:119], v2, s[36:39], s48 offen offset:1024 nt
  v_mov_b32_dpp v38, v51 row_ror:4 row_mask:0xf bank_mask:0x1
  v_mov_b32_dpp v38, v52 row_ror:8 row_mask:0xf bank_mask:0x2
  v_mov_b32_dpp v39, v51 row_ror:12 row_mask:0xf bank_mask:0x4
  v_mov_b32_dpp v39, v52 quad_perm:[0,1,2,3] row_mask:0xf bank_mask:0x8
  s_waitcnt vmcnt(12)
  v_mfma_f32_16x16x16_bf16 v[40:43], v[120:121], v[36:37], v[40:43]
  v_mfma_f32_16x16x16_bf16 v[44:47], v[122:123], v[36:37], v[44:47]
  buffer_load_dwordx4 v[120:123], v2, s[36:39], s48 offen offset:2048 nt
  s_waitcnt vmcnt(12)
  v_mfma_f32_16x16x16_bf16 v[40:43], v[124:125], v[38:39], v[40:43]
  v_mfma_f32_16x16x16_bf16 v[44:47], v[126:127], v[38:39], v[44:47]
  buffer_load_dwordx4 v[124:127], v2, s[36:39], s48 offen offset:3072 nt
  s_sub_u32 s60, s60, 1
  s_cmp_lg_u32 s60, 0
  s_cbranch_scc1 L_pace
  s_branch L_pairx
L_p0:
  s_add_u32 s48, s48, 65536
  s_waitcnt vmcnt(4)
  v_mfma_f32_16x16x32_bf16 v[16:19], v[64:67], v[12:15], 0
  buffer_load_dwordx4 v[64:67], v1, s[32:35], s48 offen offset:0 nt
  s_waitcnt vmcnt(4)
  v_mfma_f32_16x16x32_bf16 v[20:23], v[68:71], v[12:15], 0
  buffer_load_dwordx4 v[68:71], v1, s[32:35], s48 offen offset:1024 nt
  s_waitcnt vmcnt(4)
  v_mfma_f32_16x16x32_bf16 v[24:27], v[72:75], v[12:15], 0
  buffer_load_dwordx4 v[72:75], v1, s[32:35], s48 offen offset:2048 nt
  s_waitcnt vmcnt(4)
  v_mfma_f32_16x16x32_bf16 v[28:31], v[76:79], v[12:15], 0
  buffer_load_dwordx4 v[76:79], v1, s[32:35], s48 offen offset:3072 nt
  s_nop 4
  v_add_f32_dpp v48, v17, v16 row_ror:12 row_mask:0xf bank_mask:0x1
  v_add_f32_dpp v48, v18, v48 row_ror:8 row_mask:0xf bank_mask:0x1
  v_add_f32_dpp v48, v19, v48 row_ror:4 row_mask:0xf bank_mask:0x1
  v_add_f32_dpp v48, v22, v21 row_ror:12 row_mask:0xf bank_mask:0x2
  v_add_f32_dpp v48, v23, v48 row_ror:8 row_mask:0xf bank_mask:0x2
  v_add_f32_dpp v48, v20, v48 row_ror:4 row_mask:0xf bank_mask:0x2
  v_add_f32_dpp v48, v27, v26 row_ror:12 row_mask:0xf bank_mask:0x4
  v_add_f32_dpp v48, v24, v48 row_ror:8 row_mask:0xf bank_mask:0x4
  v_add_f32_dpp v48, v25, v48 row_ror:4 row_mask:0xf bank_mask:0x4
  v_add_f32_dpp v48, v28, v31 row_ror:12 row_mask:0xf bank_mask:0x8
  v_add_f32_dpp v48, v29, v48 row_ror:8 row_mask:0xf bank_mask:0x8
  v_add_f32_dpp v48, v30, v48 row_ror:4 row_mask:0xf bank_mask:0x8
  v_cvt_pk_bf16_f32 v48, 0, v48
  v_mul_f32 v48, s57, v48
  v_cvt_pk_bf16_f32 v48, 0, v48
  v_mul_f32 v49, s59, v48
  v_cmp_gt_f32 vcc, v49, v54
  s_cbranch_vccz L_nors10
  v_max_f32_dpp v49, v49, v49 row_ror:4 row_mask:0xf bank_mask:0xf
  s_nop 1
  v_max_f32_dpp v49, v49, v49 row_ror:8 row_mask:0xf bank_mask:0xf
  v_mov_b32 v50, v49
  s_nop 1
  v_permlane16_swap_b32 v49, v50
  v_max_f32 v49, v49, v50
  v_mov_b32 v50, v49
  s_nop 1
  v_permlane32_swap_b32 v49, v50
  v_max_f32 v49, v49, v50
  v_max_f32 v49, v49, v54
  v_sub_f32 v56, v54, v49
  v_exp_f32 v56, v56
  v_mov_b32 v54, v49
  v_mul_f32 v55, v55, v56
  v_mul_f32 v40, v40, v56
  v_mul_f32 v41, v41, v56
  v_mul_f32 v42, v42, v56
  v_mul_f32 v43, v43, v56
  v_mul_f32 v44, v44, v56
  v_mul_f32 v45, v45, v56
  v_mul_f32 v46, v46, v56
  v_mul_f32 v47, v47, v56
L_nors10:
  v_fma_f32 v48, v48, s59, -v54
  v_exp_f32 v48, v48
  s_nop 0
  v_cvt_pk_bf16_f32 v51, v48, 0
  v_cvt_pk_bf16_f32 v52, 0, v48
  v_add_f32 v55, v55, v48
  v_mov_b32_dpp v32, v51 quad_perm:[0,1,2,3] row_mask:0xf bank_mask:0x1
  v_mov_b32_dpp v32, v52 row_ror:4 row_mask:0xf bank_mask:0x2
  v_mov_b32_dpp v33, v51 row_ror:8 row_mask:0xf bank_mask:0x4
  v_mov_b32_dpp v33, v52 row_ror:12 row_mask:0xf bank_mask:0x8
  v_mov_b32_dpp v34, v51 row_ror:12 row_mask:0xf bank_mask:0x1
  v_mov_b32_dpp v34, v52 quad_perm:[0,1,2,3] row_mask:0xf bank_mask:0x2
  v_mov_b32_dpp v35, v51 row_ror:4 row_mask:0xf bank_mask:0x4
  v_mov_b32_dpp v35, v52 row_ror:8 row_mask:0xf bank_mask:0x8
  s_waitcnt vmcnt(4)
  v_mfma_f32_16x16x16_bf16 v[40:43], v[80:81], v[32:33], v[40:43]
  v_mfma_f32_16x16x16_bf16 v[44:47], v[82:83], v[32:33], v[44:47]
  buffer_load_dwordx4 v[80:83], v2, s[36:39], s48 offen offset:0 nt
  v_mov_b32_dpp v36, v51 row_ror:8 row_mask:0xf bank_mask:0x1
  v_mov_b32_dpp v36, v52 row_ror:12 row_mask:0xf bank_mask:0x2
  v_mov_b32_dpp v37, v51 quad_perm:[0,1,2,3] row_mask:0xf bank_mask:0x4
  v_mov_b32_dpp v37, v52 row_ror:4 row_mask:0xf bank_mask:0x8
  s_waitcnt vmcnt(4)
  v_mfma_f32_16x16x16_bf16 v[40:43], v[84:85], v[34:35], v[40:43]
  v_mfma_f32_16x16x16_bf16 v[44:47], v[86:87], v[34:35], v[44:47]
  buffer_load_dwordx4 v[84:87], v2, s[36:39], s48 offen offset:1024 nt
  v_mov_b32_dpp v38, v51 row_ror:4 row_mask:0xf bank_mask:0x1
  v_mov_b32_dpp v38, v52 row_ror:8 row_mask:0xf bank_mask:0x2
  v_mov_b32_dpp v39, v51 row_ror:12 row_mask:0xf bank_mask:0x4
  v_mov_b32_dpp v39, v52 quad_perm:[0,1,2,3] row_mask:0xf bank_mask:0x8
  s_waitcnt vmcnt(4)
  v_mfma_f32_16x16x16_bf16 v[40:43], v[88:89], v[36:37], v[40:43]
  v_mfma_f32_16x16x16_bf16 v[44:47], v[90:91], v[36:37], v[44:47]
  buffer_load_dwordx4 v[88:91], v2, s[36:39], s48 offen offset:2048 nt
  s_waitcnt vmcnt(4)
  v_mfma_f32_16x16x16_bf16 v[40:43], v[92:93], v[38:39], v[40:43]
  v_mfma_f32_16x16x16_bf16 v[44:47], v[94:95], v[38:39], v[44:47]
  buffer_load_dwordx4 v[92:95], v2, s[36:39], s48 offen offset:3072 nt
  s_add_u32 s48, s48, 65536
  s_waitcnt vmcnt(4)
  v_mfma_f32_16x16x32_bf16 v[16:19], v[96:99], v[12:15], 0
  buffer_load_dwordx4 v[96:99], v1, s[32:35], s48 offen offset:0 nt
  s_waitcnt vmcnt(4)
  v_mfma_f32_16x16x32_bf16 v[20:23], v[100:103], v[12:15], 0
  buffer_load_dwordx4 v[100:103], v1, s[32:35], s48 offen offset:1024 nt
  s_waitcnt vmcnt(4)
  v_mfma_f32_16x16x32_bf16 v[24:27], v[104:107], v[12:15], 0
  buffer_load_dwordx4 v[104:107], v1, s[32:35], s48 offen offset:2048 nt
  s_waitcnt vmcnt(4)
  v_mfma_f32_16x16x32_bf16 v[28:31], v[108:111], v[12:15], 0
  buffer_load_dwordx4 v[108:111], v1, s[32:35], s48 offen offset:3072 nt
  s_nop 4
  v_add_f32_dpp v48, v17, v16 row_ror:12 row_mask:0xf bank_mask:0x1
  v_add_f32_dpp v48, v18, v48 row_ror:8 row_mask:0xf bank_mask:0x1
  v_add_f32_dpp v48, v19, v48 row_ror:4 row_mask:0xf bank_mask:0x1
  v_add_f32_dpp v48, v22, v21 row_ror:12 row_mask:0xf bank_mask:0x2
  v_add_f32_dpp v48, v23, v48 row_ror:8 row_mask:0xf bank_mask:0x2
  v_add_f32_dpp v48, v20, v48 row_ror:4 row_mask:0xf bank_mask:0x2
  v_add_f32_dpp v48, v27, v26 row_ror:12 row_mask:0xf bank_mask:0x4
  v_add_f32_dpp v48, v24, v48 row_ror:8 row_mask:0xf bank_mask:0x4
  v_add_f32_dpp v48, v25, v48 row_ror:4 row_mask:0xf bank_mask:0x4
  v_add_f32_dpp v48, v28, v31 row_ror:12 row_mask:0xf bank_mask:0x8
  v_add_f32_dpp v48, v29, v48 row_ror:8 row_mask:0xf bank_mask:0x8
  v_add_f32_dpp v48, v30, v48 row_ror:4 row_mask:0xf bank_mask:0x8
  v_cvt_pk_bf16_f32 v48, 0, v48
  v_mul_f32 v48, s57, v48
  v_cvt_pk_bf16_f32 v48, 0, v48
  v_mul_f32 v49, s59, v48
  v_cmp_gt_f32 vcc, v49, v54
  s_cbranch_vccz L_nors11
  v_max_f32_dpp v49, v49, v49 row_ror:4 row_mask:0xf bank_mask:0xf
  s_nop 1
  v_max_f32_dpp v49, v49, v49 row_ror:8 row_mask:0xf bank_mask:0xf
  v_mov_b32 v50, v49
  s_nop 1
  v_permlane16_swap_b32 v49, v50
  v_max_f32 v49, v49, v50
  v_mov_b32 v50, v49
  s_nop 1
  v_permlane32_swap_b32 v49, v50
  v_max_f32 v49, v49, v50
  v_max_f32 v49, v49, v54
  v_sub_f32 v56, v54, v49
  v_exp_f32 v56, v56
  v_mov_b32 v54, v49
  v_mul_f32 v55, v55, v56
  v_mul_f32 v40, v40, v56
  v_mul_f32 v41, v41, v56
  v_mul_f32 v42, v42, v56
  v_mul_f32 v43, v43, v56
  v_mul_f32 v44, v44, v56
  v_mul_f32 v45, v45, v56
  v_mul_f32 v46, v46, v56
  v_mul_f32 v47, v47, v56
L_nors11:
  v_fma_f32 v48, v48, s59, -v54
  v_exp_f32 v48, v48
  s_nop 0
  v_cvt_pk_bf16_f32 v51, v48, 0
  v_cvt_pk_bf16_f32 v52, 0, v48
  v_add_f32 v55, v55, v48
  v_mov_b32_dpp v32, v51 quad_perm:[0,1,2,3] row_mask:0xf bank_mask:0x1
  v_mov_b32_dpp v32, v52 row_ror:4 row_mask:0xf bank_mask:0x2
  v_mov_b32_dpp v33, v51 row_ror:8 row_mask:0xf bank_mask:0x4
  v_mov_b32_dpp v33, v52 row_ror:12 row_mask:0xf bank_mask:0x8
  v_mov_b32_dpp v34, v51 row_ror:12 row_mask:0xf bank_mask:0x1
  v_mov_b32_dpp v34, v52 quad_perm:[0,1,2,3] row_mask:0xf bank_mask:0x2
  v_mov_b32_dpp v35, v51 row_ror:4 row_mask:0xf bank_mask:0x4
  v_mov_b32_dpp v35, v52 row_ror:8 row_mask:0xf bank_mask:0x8
  s_waitcnt vmcnt(4)
  v_mfma_f32_16x16x16_bf16 v[40:43], v[112:113], v[32:33], v[40:43]
  v_mfma_f32_16x16x16_bf16 v[44:47], v[114:115], v[32:33], v[44:47]
  buffer_load_dwordx4 v[112:115], v2, s[36:39], s48 offen offset:0 nt
  v_mov_b32_dpp v36, v51 row_ror:8 row_mask:0xf bank_mask:0x1
  v_mov_b32_dpp v36, v52 row_ror:12 row_mask:0xf bank_mask:0x2
  v_mov_b32_dpp v37, v51 quad_perm:[0,1,2,3] row_mask:0xf bank_mask:0x4
  v_mov_b32_dpp v37, v52 row_ror:4 row_mask:0xf bank_mask:0x8
  s_waitcnt vmcnt(4)
  v_mfma_f32_16x16x16_bf16 v[40:43], v[116:117], v[34:35], v[40:43]
  v_mfma_f32_16x16x16_bf16 v[44:47], v[118:119], v[34:35], v[44:47]
  buffer_load_dwordx4 v[116:119], v2, s[36:39], s48 offen offset:1024 nt
  v_mov_b32_dpp v38, v51 row_ror:4 row_mask:0xf bank_mask:0x1
  v_mov_b32_dpp v38, v52 row_ror:8 row_mask:0xf bank_mask:0x2
  v_mov_b32_dpp v39, v51 row_ror:12 row_mask:0xf bank_mask:0x4
  v_mov_b32_dpp v39, v52 quad_perm:[0,1,2,3] row_mask:0xf bank_mask:0x8
  s_waitcnt vmcnt(4)
  v_mfma_f32_16x16x16_bf16 v[40:43], v[120:121], v[36:37], v[40:43]
  v_mfma_f32_16x16x16_bf16 v[44:47], v[122:123], v[36:37], v[44:47]
  buffer_load_dwordx4 v[120:123], v2, s[36:39], s48 offen offset:2048 nt
  s_waitcnt vmcnt(4)
  v_mfma_f32_16x16x16_bf16 v[40:43], v[124:125], v[38:39], v[40:43]
  v_mfma_f32_16x16x16_bf16 v[44:47], v[126:127], v[38:39], v[44:47]
  buffer_load_dwordx4 v[124:127], v2, s[36:39], s48 offen offset:3072 nt
  s_sub_u32 s60, s60, 1
  s_cmp_lg_u32 s60, 0
  s_cbranch_scc1 L_pace
  s_branch L_pairx
L_p1:
  s_add_u32 s48, s48, 65536
  s_waitcnt vmcnt(5)
  v_mfma_f32_16x16x32_bf16 v[16:19], v[64:67], v[12:15], 0
  buffer_load_dwordx4 v[64:67], v1, s[32:35], s48 offen offset:0 nt
  s_waitcnt vmcnt(5)
  v_mfma_f32_16x16x32_bf16 v[20:23], v[68:71], v[12:15], 0
  buffer_load_dwordx4 v[68:71], v1, s[32:35], s48 offen offset:1024 nt
  s_waitcnt vmcnt(5)
  v_mfma_f32_16x16x32_bf16 v[24:27], v[72:75], v[12:15], 0
  buffer_load_dwordx4 v[72:75], v1, s[32:35], s48 offen offset:2048 nt
  s_waitcnt vmcnt(5)
  v_mfma_f32_16x16x32_bf16 v[28:31], v[76:79], v[12:15], 0
  buffer_load_dwordx4 v[76:79], v1, s[32:35], s48 offen offset:3072 nt
  s_nop 4
  v_add_f32_dpp v48, v17, v16 row_ror:12 row_mask:0xf bank_mask:0x1
  v_add_f32_dpp v48, v18, v48 row_ror:8 row_mask:0xf bank_mask:0x1
  v_add_f32_dpp v48, v19, v48 row_ror:4 row_mask:0xf bank_mask:0x1
  v_add_f32_dpp v48, v22, v21 row_ror:12 row_mask:0xf bank_mask:0x2
  v_add_f32_dpp v48, v23, v48 row_ror:8 row_mask:0xf bank_mask:0x2
  v_add_f32_dpp v48, v20, v48 row_ror:4 row_mask:0xf bank_mask:0x2
  v_add_f32_dpp v48, v27, v26 row_ror:12 row_mask:0xf bank_mask:0x4
  v_add_f32_dpp v48, v24, v48 row_ror:8 row_mask:0xf bank_mask:0x4
  v_add_f32_dpp v48, v25, v48 row_ror:4 row_mask:0xf bank_mask:0x4
  v_add_f32_dpp v48, v28, v31 row_ror:12 row_mask:0xf bank_mask:0x8
  v_add_f32_dpp v48, v29, v48 row_ror:8 row_mask:0xf bank_mask:0x8
  v_add_f32_dpp v48, v30, v48 row_ror:4 row_mask:0xf bank_mask:0x8
  v_cvt_pk_bf16_f32 v48, 0, v48
  v_mul_f32 v48, s57, v48
  v_cvt_pk_bf16_f32 v48, 0, v48
  v_mul_f32 v49, s59, v48
  v_cmp_gt_f32 vcc, v49, v54
  s_cbranch_vccz L_nors12
  v_max_f32_dpp v49, v49, v49 row_ror:4 row_mask:0xf bank_mask:0xf
  s_nop 1
  v_max_f32_dpp v49, v49, v49 row_ror:8 row_mask:0xf bank_mask:0xf
  v_mov_b32 v50, v49
  s_nop 1
  v_permlane16_swap_b32 v49, v50
  v_max_f32 v49, v49, v50
  v_mov_b32 v50, v49
  s_nop 1
  v_permlane32_swap_b32 v49, v50
  v_max_f32 v49, v49, v50
  v_max_f32 v49, v49, v54
  v_sub_f32 v56, v54, v49
  v_exp_f32 v56, v56
  v_mov_b32 v54, v49
  v_mul_f32 v55, v55, v56
  v_mul_f32 v40, v40, v56
  v_mul_f32 v41, v41, v56
  v_mul_f32 v42, v42, v56
  v_mul_f32 v43, v43, v56
  v_mul_f32 v44, v44, v56
  v_mul_f32 v45, v45, v56
  v_mul_f32 v46, v46, v56
  v_mul_f32 v47, v47, v56
L_nors12:
  v_fma_f32 v48, v48, s59, -v54
  v_exp_f32 v48, v48
  s_nop 0
  v_cvt_pk_bf16_f32 v51, v48, 0
  v_cvt_pk_bf16_f32 v52, 0, v48
  v_add_f32 v55, v55, v48
  v_mov_b32_dpp v32, v51 quad_perm:[0,1,2,3] row_mask:0xf bank_mask:0x1
  v_mov_b32_dpp v32, v52 row_ror:4 row_mask:0xf bank_mask:0x2
  v_mov_b32_dpp v33, v51 row_ror:8 row_mask:0xf bank_mask:0x4
  v_mov_b32_dpp v33, v52 row_ror:12 row_mask:0xf bank_mask:0x8
  v_mov_b32_dpp v34, v51 row_ror:12 row_mask:0xf bank_mask:0x1
  v_mov_b32_dpp v34, v52 quad_perm:[0,1,2,3] row_mask:0xf bank_mask:0x2
  v_mov_b32_dpp v35, v51 row_ror:4 row_mask:0xf bank_mask:0x4
  v_mov_b32_dpp v35, v52 row_ror:8 row_mask:0xf bank_mask:0x8
  s_waitcnt vmcnt(5)
  v_mfma_f32_16x16x16_bf16 v[40:43], v[80:81], v[32:33], v[40:43]
  v_mfma_f32_16x16x16_bf16 v[44:47], v[82:83], v[32:33], v[44:47]
  buffer_load_dwordx4 v[80:83], v2, s[36:39], s48 offen offset:0 nt
  v_mov_b32_dpp v36, v51 row_ror:8 row_mask:0xf bank_mask:0x1
  v_mov_b32_dpp v36, v52 row_ror:12 row_mask:0xf bank_mask:0x2
  v_mov_b32_dpp v37, v51 quad_perm:[0,1,2,3] row_mask:0xf bank_mask:0x4
  v_mov_b32_dpp v37, v52 row_ror:4 row_mask:0xf bank_mask:0x8
  s_waitcnt vmcnt(5)
  v_mfma_f32_16x16x16_bf16 v[40:43], v[84:85], v[34:35], v[40:43]
  v_mfma_f32_16x16x16_bf16 v[44:47], v[86:87], v[34:35], v[44:47]
  buffer_load_dwordx4 v[84:87], v2, s[36:39], s48 offen offset:1024 nt
  v_mov_b32_dpp v38, v51 row_ror:4 row_mask:0xf bank_mask:0x1
  v_mov_b32_dpp v38, v52 row_ror:8 row_mask:0xf bank_mask:0x2
  v_mov_b32_dpp v39, v51 row_ror:12 row_mask:0xf bank_mask:0x4
  v_mov_b32_dpp v39, v52 quad_perm:[0,1,2,3] row_mask:0xf bank_mask:0x8
  s_waitcnt vmcnt(5)
  v_mfma_f32_16x16x16_bf16 v[40:43], v[88:89], v[36:37], v[40:43]
  v_mfma_f32_16x16x16_bf16 v[44:47], v[90:91], v[36:37], v[44:47]
  buffer_load_dwordx4 v[88:91], v2, s[36:39], s48 offen offset:2048 nt
  s_waitcnt vmcnt(5)
  v_mfma_f32_16x16x16_bf16 v[40:43], v[92:93], v[38:39], v[40:43]
  v_mfma_f32_16x16x16_bf16 v[44:47], v[94:95], v[38:39], v[44:47]
  buffer_load_dwordx4 v[92:95], v2, s[36:39], s48 offen offset:3072 nt
  s_add_u32 s48, s48, 65536
  s_waitcnt vmcnt(5)
  v_mfma_f32_16x16x32_bf16 v[16:19], v[96:99], v[12:15], 0
  buffer_load_dwordx4 v[96:99], v1, s[32:35], s48 offen offset:0 nt
  s_waitcnt vmcnt(5)
  v_mfma_f32_16x16x32_bf16 v[20:23], v[100:103], v[12:15], 0
  buffer_load_dwordx4 v[100:103], v1, s[32:35], s48 offen offset:1024 nt
  s_waitcnt vmcnt(5)
  v_mfma_f32_16x16x32_bf16 v[24:27], v[104:107], v[12:15], 0
  buffer_load_dwordx4 v[104:107], v1, s[32:35], s48 offen offset:2048 nt
  s_waitcnt vmcnt(5)
  v_mfma_f32_16x16x32_bf16 v[28:31], v[108:111], v[12:15], 0
  buffer_load_dwordx4 v[108:111], v1, s[32:35], s48 offen offset:3072 nt
  s_nop 4
  v_add_f32_dpp v48, v17, v16 row_ror:12 row_mask:0xf bank_mask:0x1
  v_add_f32_dpp v48, v18, v48 row_ror:8 row_mask:0xf bank_mask:0x1
  v_add_f32_dpp v48, v19, v48 row_ror:4 row_mask:0xf bank_mask:0x1
  v_add_f32_dpp v48, v22, v21 row_ror:12 row_mask:0xf bank_mask:0x2
  v_add_f32_dpp v48, v23, v48 row_ror:8 row_mask:0xf bank_mask:0x2
  v_add_f32_dpp v48, v20, v48 row_ror:4 row_mask:0xf bank_mask:0x2
  v_add_f32_dpp v48, v27, v26 row_ror:12 row_mask:0xf bank_mask:0x4
  v_add_f32_dpp v48, v24, v48 row_ror:8 row_mask:0xf bank_mask:0x4
  v_add_f32_dpp v48, v25, v48 row_ror:4 row_mask:0xf bank_mask:0x4
  v_add_f32_dpp v48, v28, v31 row_ror:12 row_mask:0xf bank_mask:0x8
  v_add_f32_dpp v48, v29, v48 row_ror:8 row_mask:0xf bank_mask:0x8
  v_add_f32_dpp v48, v30, v48 row_ror:4 row_mask:0xf bank_mask:0x8
  v_cvt_pk_bf16_f32 v48, 0, v48
  v_mul_f32 v48, s57, v48
  v_cvt_pk_bf16_f32 v48, 0, v48
  v_mul_f32 v49, s59, v48
  v_cmp_gt_f32 vcc, v49, v54
  s_cbranch_vccz L_nors13
  v_max_f32_dpp v49, v49, v49 row_ror:4 row_mask:0xf bank_mask:0xf
  s_nop 1
  v_max_f32_dpp v49, v49, v49 row_ror:8 row_mask:0xf bank_mask:0xf
  v_mov_b32 v50, v49
  s_nop 1
  v_permlane16_swap_b32 v49, v50
  v_max_f32 v49, v49, v50
  v_mov_b32 v50, v49
  s_nop 1
  v_permlane32_swap_b32 v49, v50
  v_max_f32 v49, v49, v50
  v_max_f32 v49, v49, v54
  v_sub_f32 v56, v54, v49
  v_exp_f32 v56, v56
  v_mov_b32 v54, v49
  v_mul_f32 v55, v55, v56
  v_mul_f32 v40, v40, v56
  v_mul_f32 v41, v41, v56
  v_mul_f32 v42, v42, v56
  v_mul_f32 v43, v43, v56
  v_mul_f32 v44, v44, v56
  v_mul_f32 v45, v45, v56
  v_mul_f32 v46, v46, v56
  v_mul_f32 v47, v47, v56
L_nors13:
  v_fma_f32 v48, v48, s59, -v54
  v_exp_f32 v48, v48
  s_nop 0
  v_cvt_pk_bf16_f32 v51, v48, 0
  v_cvt_pk_bf16_f32 v52, 0, v48
  v_add_f32 v55, v55, v48
  v_mov_b32_dpp v32, v51 quad_perm:[0,1,2,3] row_mask:0xf bank_mask:0x1
  v_mov_b32_dpp v32, v52 row_ror:4 row_mask:0xf bank_mask:0x2
  v_mov_b32_dpp v33, v51 row_ror:8 row_mask:0xf bank_mask:0x4
  v_mov_b32_dpp v33, v52 row_ror:12 row_mask:0xf bank_mask:0x8
  v_mov_b32_dpp v34, v51 row_ror:12 row_mask:0xf bank_mask:0x1
  v_mov_b32_dpp v34, v52 quad_perm:[0,1,2,3] row_mask:0xf bank_mask:0x2
  v_mov_b32_dpp v35, v51 row_ror:4 row_mask:0xf bank_mask:0x4
  v_mov_b32_dpp v35, v52 row_ror:8 row_mask:0xf bank_mask:0x8
  s_waitcnt vmcnt(5)
  v_mfma_f32_16x16x16_bf16 v[40:43], v[112:113], v[32:33], v[40:43]
  v_mfma_f32_16x16x16_bf16 v[44:47], v[114:115], v[32:33], v[44:47]
  buffer_load_dwordx4 v[112:115], v2, s[36:39], s48 offen offset:0 nt
  v_mov_b32_dpp v36, v51 row_ror:8 row_mask:0xf bank_mask:0x1
  v_mov_b32_dpp v36, v52 row_ror:12 row_mask:0xf bank_mask:0x2
  v_mov_b32_dpp v37, v51 quad_perm:[0,1,2,3] row_mask:0xf bank_mask:0x4
  v_mov_b32_dpp v37, v52 row_ror:4 row_mask:0xf bank_mask:0x8
  s_waitcnt vmcnt(5)
  v_mfma_f32_16x16x16_bf16 v[40:43], v[116:117], v[34:35], v[40:43]
  v_mfma_f32_16x16x16_bf16 v[44:47], v[118:119], v[34:35], v[44:47]
  buffer_load_dwordx4 v[116:119], v2, s[36:39], s48 offen offset:1024 nt
  v_mov_b32_dpp v38, v51 row_ror:4 row_mask:0xf bank_mask:0x1
  v_mov_b32_dpp v38, v52 row_ror:8 row_mask:0xf bank_mask:0x2
  v_mov_b32_dpp v39, v51 row_ror:12 row_mask:0xf bank_mask:0x4
  v_mov_b32_dpp v39, v52 quad_perm:[0,1,2,3] row_mask:0xf bank_mask:0x8
  s_waitcnt vmcnt(5)
  v_mfma_f32_16x16x16_bf16 v[40:43], v[120:121], v[36:37], v[40:43]
  v_mfma_f32_16x16x16_bf16 v[44:47], v[122:123], v[36:37], v[44:47]
  buffer_load_dwordx4 v[120:123], v2, s[36:39], s48 offen offset:2048 nt
  s_waitcnt vmcnt(5)
  v_mfma_f32_16x16x16_bf16 v[40:43], v[124:125], v[38:39], v[40:43]
  v_mfma_f32_16x16x16_bf16 v[44:47], v[126:127], v[38:39], v[44:47]
  buffer_load_dwordx4 v[124:127], v2, s[36:39], s48 offen offset:3072 nt
  s_sub_u32 s60, s60, 1
  s_cmp_lg_u32 s60, 0
  s_cbranch_scc1 L_pace
  s_branch L_pairx
L_p2:
  s_add_u32 s48, s48, 65536
  s_waitcnt vmcnt(7)
  v_mfma_f32_16x16x32_bf16 v[16:19], v[64:67], v[12:15], 0
  buffer_load_dwordx4 v[64:67], v1, s[32:35], s48 offen offset:0 nt
  s_waitcnt vmcnt(7)
  v_mfma_f32_16x16x32_bf16 v[20:23], v[68:71], v[12:15], 0
  buffer_load_dwordx4 v[68:71], v1, s[32:35], s48 offen offset:1024 nt
  s_waitcnt vmcnt(7)
  v_mfma_f32_16x16x32_bf16 v[24:27], v[72:75], v[12:15], 0
  buffer_load_dwordx4 v[72:75], v1, s[32:35], s48 offen offset:2048 nt
  s_waitcnt vmcnt(7)
  v_mfma_f32_16x16x32_bf16 v[28:31], v[76:79], v[12:15], 0
  buffer_load_dwordx4 v[76:79], v1, s[32:35], s48 offen offset:3072 nt
  s_nop 4
  v_add_f32_dpp v48, v17, v16 row_ror:12 row_mask:0xf bank_mask:0x1
  v_add_f32_dpp v48, v18, v48 row_ror:8 row_mask:0xf bank_mask:0x1
  v_add_f32_dpp v48, v19, v48 row_ror:4 row_mask:0xf bank_mask:0x1
  v_add_f32_dpp v48, v22, v21 row_ror:12 row_mask:0xf bank_mask:0x2
  v_add_f32_dpp v48, v23, v48 row_ror:8 row_mask:0xf bank_mask:0x2
  v_add_f32_dpp v48, v20, v48 row_ror:4 row_mask:0xf bank_mask:0x2
  v_add_f32_dpp v48, v27, v26 row_ror:12 row_mask:0xf bank_mask:0x4
  v_add_f32_dpp v48, v24, v48 row_ror:8 row_mask:0xf bank_mask:0x4
  v_add_f32_dpp v48, v25, v48 row_ror:4 row_mask:0xf bank_mask:0x4
  v_add_f32_dpp v48, v28, v31 row_ror:12 row_mask:0xf bank_mask:0x8
  v_add_f32_dpp v48, v29, v48 row_ror:8 row_mask:0xf bank_mask:0x8
  v_add_f32_dpp v48, v30, v48 row_ror:4 row_mask:0xf bank_mask:0x8
  v_cvt_pk_bf16_f32 v48, 0, v48
  v_mul_f32 v48, s57, v48
  v_cvt_pk_bf16_f32 v48, 0, v48
  v_mul_f32 v49, s59, v48
  v_cmp_gt_f32 vcc, v49, v54
  s_cbranch_vccz L_nors14
  v_max_f32_dpp v49, v49, v49 row_ror:4 row_mask:0xf bank_mask:0xf
  s_nop 1
  v_max_f32_dpp v49, v49, v49 row_ror:8 row_mask:0xf bank_mask:0xf
  v_mov_b32 v50, v49
  s_nop 1
  v_permlane16_swap_b32 v49, v50
  v_max_f32 v49, v49, v50
  v_mov_b32 v50, v49
  s_nop 1
  v_permlane32_swap_b32 v49, v50
  v_max_f32 v49, v49, v50
  v_max_f32 v49, v49, v54
  v_sub_f32 v56, v54, v49
  v_exp_f32 v56, v56
  v_mov_b32 v54, v49
  v_mul_f32 v55, v55, v56
  v_mul_f32 v40, v40, v56
  v_mul_f32 v41, v41, v56
  v_mul_f32 v42, v42, v56
  v_mul_f32 v43, v43, v56
  v_mul_f32 v44, v44, v56
  v_mul_f32 v45, v45, v56
  v_mul_f32 v46, v46, v56
  v_mul_f32 v47, v47, v56
L_nors14:
  v_fma_f32 v48, v48, s59, -v54
  v_exp_f32 v48, v48
  s_nop 0
  v_cvt_pk_bf16_f32 v51, v48, 0
  v_cvt_pk_bf16_f32 v52, 0, v48
  v_add_f32 v55, v55, v48
  v_mov_b32_dpp v32, v51 quad_perm:[0,1,2,3] row_mask:0xf bank_mask:0x1
  v_mov_b32_dpp v32, v52 row_ror:4 row_mask:0xf bank_mask:0x2
  v_mov_b32_dpp v33, v51 row_ror:8 row_mask:0xf bank_mask:0x4
  v_mov_b32_dpp v33, v52 row_ror:12 row_mask:0xf bank_mask:0x8
  v_mov_b32_dpp v34, v51 row_ror:12 row_mask:0xf bank_mask:0x1
  v_mov_b32_dpp v34, v52 quad_perm:[0,1,2,3] row_mask:0xf bank_mask:0x2
  v_mov_b32_dpp v35, v51 row_ror:4 row_mask:0xf bank_mask:0x4
  v_mov_b32_dpp v35, v52 row_ror:8 row_mask:0xf bank_mask:0x8
  s_waitcnt vmcnt(7)
  v_mfma_f32_16x16x16_bf16 v[40:43], v[80:81], v[32:33], v[40:43]
  v_mfma_f32_16x16x16_bf16 v[44:47], v[82:83], v[32:33], v[44:47]
  buffer_load_dwordx4 v[80:83], v2, s[36:39], s48 offen offset:0 nt
  v_mov_b32_dpp v36, v51 row_ror:8 row_mask:0xf bank_mask:0x1
  v_mov_b32_dpp v36, v52 row_ror:12 row_mask:0xf bank_mask:0x2
  v_mov_b32_dpp v37, v51 quad_perm:[0,1,2,3] row_mask:0xf bank_mask:0x4
  v_mov_b32_dpp v37, v52 row_ror:4 row_mask:0xf bank_mask:0x8
  s_waitcnt vmcnt(7)
  v_mfma_f32_16x16x16_bf16 v[40:43], v[84:85], v[34:35], v[40:43]
  v_mfma_f32_16x16x16_bf16 v[44:47], v[86:87], v[34:35], v[44:47]
  buffer_load_dwordx4 v[84:87], v2, s[36:39], s48 offen offset:1024 nt
  v_mov_b32_dpp v38, v51 row_ror:4 row_mask:0xf bank_mask:0x1
  v_mov_b32_dpp v38, v52 row_ror:8 row_mask:0xf bank_mask:0x2
  v_mov_b32_dpp v39, v51 row_ror:12 row_mask:0xf bank_mask:0x4
  v_mov_b32_dpp v39, v52 quad_perm:[0,1,2,3] row_mask:0xf bank_mask:0x8
  s_waitcnt vmcnt(7)
  v_mfma_f32_16x16x16_bf16 v[40:43], v[88:89], v[36:37], v[40:43]
  v_mfma_f32_16x16x16_bf16 v[44:47], v[90:91], v[36:37], v[44:47]
  buffer_load_dwordx4 v[88:91], v2, s[36:39], s48 offen offset:2048 nt
  s_waitcnt vmcnt(7)
  v_mfma_f32_16x16x16_bf16 v[40:43], v[92:93], v[38:39], v[40:43]
  v_mfma_f32_16x16x16_bf16 v[44:47], v[94:95], v[38:39], v[44:47]
  buffer_load_dwordx4 v[92:95], v2, s[36:39], s48 offen offset:3072 nt
  s_add_u32 s48, s48, 65536
  s_waitcnt vmcnt(7)
  v_mfma_f32_16x16x32_bf16 v[16:19], v[96:99], v[12:15], 0
  buffer_load_dwordx4 v[96:99], v1, s[32:35], s48 offen offset:0 nt
  s_waitcnt vmcnt(7)
  v_mfma_f32_16x16x32_bf16 v[20:23], v[100:103], v[12:15], 0
  buffer_load_dwordx4 v[100:103], v1, s[32:35], s48 offen offset:1024 nt
  s_waitcnt vmcnt(7)
  v_mfma_f32_16x16x32_bf16 v[24:27], v[104:107], v[12:15], 0
  buffer_load_dwordx4 v[104:107], v1, s[32:35], s48 offen offset:2048 nt
  s_waitcnt vmcnt(7)
  v_mfma_f32_16x16x32_bf16 v[28:31], v[108:111], v[12:15], 0
  buffer_load_dwordx4 v[108:111], v1, s[32:35], s48 offen offset:3072 nt
  s_nop 4
  v_add_f32_dpp v48, v17, v16 row_ror:12 row_mask:0xf bank_mask:0x1
  v_add_f32_dpp v48, v18, v48 row_ror:8 row_mask:0xf bank_mask:0x1
  v_add_f32_dpp v48, v19, v48 row_ror:4 row_mask:0xf bank_mask:0x1
  v_add_f32_dpp v48, v22, v21 row_ror:12 row_mask:0xf bank_mask:0x2
  v_add_f32_dpp v48, v23, v48 row_ror:8 row_mask:0xf bank_mask:0x2
  v_add_f32_dpp v48, v20, v48 row_ror:4 row_mask:0xf bank_mask:0x2
  v_add_f32_dpp v48, v27, v26 row_ror:12 row_mask:0xf bank_mask:0x4
  v_add_f32_dpp v48, v24, v48 row_ror:8 row_mask:0xf bank_mask:0x4
  v_add_f32_dpp v48, v25, v48 row_ror:4 row_mask:0xf bank_mask:0x4
  v_add_f32_dpp v48, v28, v31 row_ror:12 row_mask:0xf bank_mask:0x8
  v_add_f32_dpp v48, v29, v48 row_ror:8 row_mask:0xf bank_mask:0x8
  v_add_f32_dpp v48, v30, v48 row_ror:4 row_mask:0xf bank_mask:0x8
  v_cvt_pk_bf16_f32 v48, 0, v48
  v_mul_f32 v48, s57, v48
  v_cvt_pk_bf16_f32 v48, 0, v48
  v_mul_f32 v49, s59, v48
  v_cmp_gt_f32 vcc, v49, v54
  s_cbranch_vccz L_nors15
  v_max_f32_dpp v49, v49, v49 row_ror:4 row_mask:0xf bank_mask:0xf
  s_nop 1
  v_max_f32_dpp v49, v49, v49 row_ror:8 row_mask:0xf bank_mask:0xf
  v_mov_b32 v50, v49
  s_nop 1
  v_permlane16_swap_b32 v49, v50
  v_max_f32 v49, v49, v50
  v_mov_b32 v50, v49
  s_nop 1
  v_permlane32_swap_b32 v49, v50
  v_max_f32 v49, v49, v50
  v_max_f32 v49, v49, v54
  v_sub_f32 v56, v54, v49
  v_exp_f32 v56, v56
  v_mov_b32 v54, v49
  v_mul_f32 v55, v55, v56
  v_mul_f32 v40, v40, v56
  v_mul_f32 v41, v41, v56
  v_mul_f32 v42, v42, v56
  v_mul_f32 v43, v43, v56
  v_mul_f32 v44, v44, v56
  v_mul_f32 v45, v45, v56
  v_mul_f32 v46, v46, v56
  v_mul_f32 v47, v47, v56
L_nors15:
  v_fma_f32 v48, v48, s59, -v54
  v_exp_f32 v48, v48
  s_nop 0
  v_cvt_pk_bf16_f32 v51, v48, 0
  v_cvt_pk_bf16_f32 v52, 0, v48
  v_add_f32 v55, v55, v48
  v_mov_b32_dpp v32, v51 quad_perm:[0,1,2,3] row_mask:0xf bank_mask:0x1
  v_mov_b32_dpp v32, v52 row_ror:4 row_mask:0xf bank_mask:0x2
  v_mov_b32_dpp v33, v51 row_ror:8 row_mask:0xf bank_mask:0x4
  v_mov_b32_dpp v33, v52 row_ror:12 row_mask:0xf bank_mask:0x8
  v_mov_b32_dpp v34, v51 row_ror:12 row_mask:0xf bank_mask:0x1
  v_mov_b32_dpp v34, v52 quad_perm:[0,1,2,3] row_mask:0xf bank_mask:0x2
  v_mov_b32_dpp v35, v51 row_ror:4 row_mask:0xf bank_mask:0x4
  v_mov_b32_dpp v35, v52 row_ror:8 row_mask:0xf bank_mask:0x8
  s_waitcnt vmcnt(7)
  v_mfma_f32_16x16x16_bf16 v[40:43], v[112:113], v[32:33], v[40:43]
  v_mfma_f32_16x16x16_bf16 v[44:47], v[114:115], v[32:33], v[44:47]
  buffer_load_dwordx4 v[112:115], v2, s[36:39], s48 offen offset:0 nt
  v_mov_b32_dpp v36, v51 row_ror:8 row_mask:0xf bank_mask:0x1
  v_mov_b32_dpp v36, v52 row_ror:12 row_mask:0xf bank_mask:0x2
  v_mov_b32_dpp v37, v51 quad_perm:[0,1,2,3] row_mask:0xf bank_mask:0x4
  v_mov_b32_dpp v37, v52 row_ror:4 row_mask:0xf bank_mask:0x8
  s_waitcnt vmcnt(7)
  v_mfma_f32_16x16x16_bf16 v[40:43], v[116:117], v[34:35], v[40:43]
  v_mfma_f32_16x16x16_bf16 v[44:47], v[118:119], v[34:35], v[44:47]
  buffer_load_dwordx4 v[116:119], v2, s[36:39], s48 offen offset:1024 nt
  v_mov_b32_dpp v38, v51 row_ror:4 row_mask:0xf bank_mask:0x1
  v_mov_b32_dpp v38, v52 row_ror:8 row_mask:0xf bank_mask:0x2
  v_mov_b32_dpp v39, v51 row_ror:12 row_mask:0xf bank_mask:0x4
  v_mov_b32_dpp v39, v52 quad_perm:[0,1,2,3] row_mask:0xf bank_mask:0x8
  s_waitcnt vmcnt(7)
  v_mfma_f32_16x16x16_bf16 v[40:43], v[120:121], v[36:37], v[40:43]
  v_mfma_f32_16x16x16_bf16 v[44:47], v[122:123], v[36:37], v[44:47]
  buffer_load_dwordx4 v[120:123], v2, s[36:39], s48 offen offset:2048 nt
  s_waitcnt vmcnt(7)
  v_mfma_f32_16x16x16_bf16 v[40:43], v[124:125], v[38:39], v[40:43]
  v_mfma_f32_16x16x16_bf16 v[44:47], v[126:127], v[38:39], v[44:47]
  buffer_load_dwordx4 v[124:127], v2, s[36:39], s48 offen offset:3072 nt
  s_sub_u32 s60, s60, 1
  s_cmp_lg_u32 s60, 0
  s_cbranch_scc1 L_pace
  s_branch L_pairx
L_p3:
  s_add_u32 s48, s48, 65536
  s_waitcnt vmcnt(9)
  v_mfma_f32_16x16x32_bf16 v[16:19], v[64:67], v[12:15], 0
  buffer_load_dwordx4 v[64:67], v1, s[32:35], s48 offen offset:0 nt
  s_waitcnt vmcnt(9)
  v_mfma_f32_16x16x32_bf16 v[20:23], v[68:71], v[12:15], 0
  buffer_load_dwordx4 v[68:71], v1, s[32:35], s48 offen offset:1024 nt
  s_waitcnt vmcnt(9)
  v_mfma_f32_16x16x32_bf16 v[24:27], v[72:75], v[12:15], 0
  buffer_load_dwordx4 v[72:75], v1, s[32:35], s48 offen offset:2048 nt
  s_waitcnt vmcnt(9)
  v_mfma_f32_16x16x32_bf16 v[28:31], v[76:79], v[12:15], 0
  buffer_load_dwordx4 v[76:79], v1, s[32:35], s48 offen offset:3072 nt
  s_nop 4
  v_add_f32_dpp v48, v17, v16 row_ror:12 row_mask:0xf bank_mask:0x1
  v_add_f32_dpp v48, v18, v48 row_ror:8 row_mask:0xf bank_mask:0x1
  v_add_f32_dpp v48, v19, v48 row_ror:4 row_mask:0xf bank_mask:0x1
  v_add_f32_dpp v48, v22, v21 row_ror:12 row_mask:0xf bank_mask:0x2
  v_add_f32_dpp v48, v23, v48 row_ror:8 row_mask:0xf bank_mask:0x2
  v_add_f32_dpp v48, v20, v48 row_ror:4 row_mask:0xf bank_mask:0x2
  v_add_f32_dpp v48, v27, v26 row_ror:12 row_mask:0xf bank_mask:0x4
  v_add_f32_dpp v48, v24, v48 row_ror:8 row_mask:0xf bank_mask:0x4
  v_add_f32_dpp v48, v25, v48 row_ror:4 row_mask:0xf bank_mask:0x4
  v_add_f32_dpp v48, v28, v31 row_ror:12 row_mask:0xf bank_mask:0x8
  v_add_f32_dpp v48, v29, v48 row_ror:8 row_mask:0xf bank_mask:0x8
  v_add_f32_dpp v48, v30, v48 row_ror:4 row_mask:0xf bank_mask:0x8
  v_cvt_pk_bf16_f32 v48, 0, v48
  v_mul_f32 v48, s57, v48
  v_cvt_pk_bf16_f32 v48, 0, v48
  v_mul_f32 v49, s59, v48
  v_cmp_gt_f32 vcc, v49, v54
  s_cbranch_vccz L_nors16
  v_max_f32_dpp v49, v49, v49 row_ror:4 row_mask:0xf bank_mask:0xf
  s_nop 1
  v_max_f32_dpp v49, v49, v49 row_ror:8 row_mask:0xf bank_mask:0xf
  v_mov_b32 v50, v49
  s_nop 1
  v_permlane16_swap_b32 v49, v50
  v_max_f32 v49, v49, v50
  v_mov_b32 v50, v49
  s_nop 1
  v_permlane32_swap_b32 v49, v50
  v_max_f32 v49, v49, v50
  v_max_f32 v49, v49, v54
  v_sub_f32 v56, v54, v49
  v_exp_f32 v56, v56
  v_mov_b32 v54, v49
  v_mul_f32 v55, v55, v56
  v_mul_f32 v40, v40, v56
  v_mul_f32 v41, v41, v56
  v_mul_f32 v42, v42, v56
  v_mul_f32 v43, v43, v56
  v_mul_f32 v44, v44, v56
  v_mul_f32 v45, v45, v56
  v_mul_f32 v46, v46, v56
  v_mul_f32 v47, v47, v56
L_nors16:
  v_fma_f32 v48, v48, s59, -v54
  v_exp_f32 v48, v48
  s_nop 0
  v_cvt_pk_bf16_f32 v51, v48, 0
  v_cvt_pk_bf16_f32 v52, 0, v48
  v_add_f32 v55, v55, v48
  v_mov_b32_dpp v32, v51 quad_perm:[0,1,2,3] row_mask:0xf bank_mask:0x1
  v_mov_b32_dpp v32, v52 row_ror:4 row_mask:0xf bank_mask:0x2
  v_mov_b32_dpp v33, v51 row_ror:8 row_mask:0xf bank_mask:0x4
  v_mov_b32_dpp v33, v52 row_ror:12 row_mask:0xf bank_mask:0x8
  v_mov_b32_dpp v34, v51 row_ror:12 row_mask:0xf bank_mask:0x1
  v_mov_b32_dpp v34, v52 quad_perm:[0,1,2,3] row_mask:0xf bank_mask:0x2
  v_mov_b32_dpp v35, v51 row_ror:4 row_mask:0xf bank_mask:0x4
  v_mov_b32_dpp v35, v52 row_ror:8 row_mask:0xf bank_mask:0x8
  s_waitcnt vmcnt(9)
  v_mfma_f32_16x16x16_bf16 v[40:43], v[80:81], v[32:33], v[40:43]
  v_mfma_f32_16x16x16_bf16 v[44:47], v[82:83], v[32:33], v[44:47]
  buffer_load_dwordx4 v[80:83], v2, s[36:39], s48 offen offset:0 nt
  v_mov_b32_dpp v36, v51 row_ror:8 row_mask:0xf bank_mask:0x1
  v_mov_b32_dpp v36, v52 row_ror:12 row_mask:0xf bank_mask:0x2
  v_mov_b32_dpp v37, v51 quad_perm:[0,1,2,3] row_mask:0xf bank_mask:0x4
  v_mov_b32_dpp v37, v52 row_ror:4 row_mask:0xf bank_mask:0x8
  s_waitcnt vmcnt(9)
  v_mfma_f32_16x16x16_bf16 v[40:43], v[84:85], v[34:35], v[40:43]
  v_mfma_f32_16x16x16_bf16 v[44:47], v[86:87], v[34:35], v[44:47]
  buffer_load_dwordx4 v[84:87], v2, s[36:39], s48 offen offset:1024 nt
  v_mov_b32_dpp v38, v51 row_ror:4 row_mask:0xf bank_mask:0x1
  v_mov_b32_dpp v38, v52 row_ror:8 row_mask:0xf bank_mask:0x2
  v_mov_b32_dpp v39, v51 row_ror:12 row_mask:0xf bank_mask:0x4
  v_mov_b32_dpp v39, v52 quad_perm:[0,1,2,3] row_mask:0xf bank_mask:0x8
  s_waitcnt vmcnt(9)
  v_mfma_f32_16x16x16_bf16 v[40:43], v[88:89], v[36:37], v[40:43]
  v_mfma_f32_16x16x16_bf16 v[44:47], v[90:91], v[36:37], v[44:47]
  buffer_load_dwordx4 v[88:91], v2, s[36:39], s48 offen offset:2048 nt
  s_waitcnt vmcnt(9)
  v_mfma_f32_16x16x16_bf16 v[40:43], v[92:93], v[38:39], v[40:43]
  v_mfma_f32_16x16x16_bf16 v[44:47], v[94:95], v[38:39], v[44:47]
  buffer_load_dwordx4 v[92:95], v2, s[36:39], s48 offen offset:3072 nt
  s_add_u32 s48, s48, 65536
  s_waitcnt vmcnt(9)
  v_mfma_f32_16x16x32_bf16 v[16:19], v[96:99], v[12:15], 0
  buffer_load_dwordx4 v[96:99], v1, s[32:35], s48 offen offset:0 nt
  s_waitcnt vmcnt(9)
  v_mfma_f32_16x16x32_bf16 v[20:23], v[100:103], v[12:15], 0
  buffer_load_dwordx4 v[100:103], v1, s[32:35], s48 offen offset:1024 nt
  s_waitcnt vmcnt(9)
  v_mfma_f32_16x16x32_bf16 v[24:27], v[104:107], v[12:15], 0
  buffer_load_dwordx4 v[104:107], v1, s[32:35], s48 offen offset:2048 nt
  s_waitcnt vmcnt(9)
  v_mfma_f32_16x16x32_bf16 v[28:31], v[108:111], v[12:15], 0
  buffer_load_dwordx4 v[108:111], v1, s[32:35], s48 offen offset:3072 nt
  s_nop 4
  v_add_f32_dpp v48, v17, v16 row_ror:12 row_mask:0xf bank_mask:0x1
  v_add_f32_dpp v48, v18, v48 row_ror:8 row_mask:0xf bank_mask:0x1
  v_add_f32_dpp v48, v19, v48 row_ror:4 row_mask:0xf bank_mask:0x1
  v_add_f32_dpp v48, v22, v21 row_ror:12 row_mask:0xf bank_mask:0x2
  v_add_f32_dpp v48, v23, v48 row_ror:8 row_mask:0xf bank_mask:0x2
  v_add_f32_dpp v48, v20, v48 row_ror:4 row_mask:0xf bank_mask:0x2
  v_add_f32_dpp v48, v27, v26 row_ror:12 row_mask:0xf bank_mask:0x4
  v_add_f32_dpp v48, v24, v48 row_ror:8 row_mask:0xf bank_mask:0x4
  v_add_f32_dpp v48, v25, v48 row_ror:4 row_mask:0xf bank_mask:0x4
  v_add_f32_dpp v48, v28, v31 row_ror:12 row_mask:0xf bank_mask:0x8
  v_add_f32_dpp v48, v29, v48 row_ror:8 row_mask:0xf bank_mask:0x8
  v_add_f32_dpp v48, v30, v48 row_ror:4 row_mask:0xf bank_mask:0x8
  v_cvt_pk_bf16_f32 v48, 0, v48
  v_mul_f32 v48, s57, v48
  v_cvt_pk_bf16_f32 v48, 0, v48
  v_mul_f32 v49, s59, v48
  v_cmp_gt_f32 vcc, v49, v54
  s_cbranch_vccz L_nors17
  v_max_f32_dpp v49, v49, v49 row_ror:4 row_mask:0xf bank_mask:0xf
  s_nop 1
  v_max_f32_dpp v49, v49, v49 row_ror:8 row_mask:0xf bank_mask:0xf
  v_mov_b32 v50, v49
  s_nop 1
  v_permlane16_swap_b32 v49, v50
  v_max_f32 v49, v49, v50
  v_mov_b32 v50, v49
  s_nop 1
  v_permlane32_swap_b32 v49, v50
  v_max_f32 v49, v49, v50
  v_max_f32 v49, v49, v54
  v_sub_f32 v56, v54, v49
  v_exp_f32 v56, v56
  v_mov_b32 v54, v49
  v_mul_f32 v55, v55, v56
  v_mul_f32 v40, v40, v56
  v_mul_f32 v41, v41, v56
  v_mul_f32 v42, v42, v56
  v_mul_f32 v43, v43, v56
  v_mul_f32 v44, v44, v56
  v_mul_f32 v45, v45, v56
  v_mul_f32 v46, v46, v56
  v_mul_f32 v47, v47, v56
L_nors17:
  v_fma_f32 v48, v48, s59, -v54
  v_exp_f32 v48, v48
  s_nop 0
  v_cvt_pk_bf16_f32 v51, v48, 0
  v_cvt_pk_bf16_f32 v52, 0, v48
  v_add_f32 v55, v55, v48
  v_mov_b32_dpp v32, v51 quad_perm:[0,1,2,3] row_mask:0xf bank_mask:0x1
  v_mov_b32_dpp v32, v52 row_ror:4 row_mask:0xf bank_mask:0x2
  v_mov_b32_dpp v33, v51 row_ror:8 row_mask:0xf bank_mask:0x4
  v_mov_b32_dpp v33, v52 row_ror:12 row_mask:0xf bank_mask:0x8
  v_mov_b32_dpp v34, v51 row_ror:12 row_mask:0xf bank_mask:0x1
  v_mov_b32_dpp v34, v52 quad_perm:[0,1,2,3] row_mask:0xf bank_mask:0x2
  v_mov_b32_dpp v35, v51 row_ror:4 row_mask:0xf bank_mask:0x4
  v_mov_b32_dpp v35, v52 row_ror:8 row_mask:0xf bank_mask:0x8
  s_waitcnt vmcnt(9)
  v_mfma_f32_16x16x16_bf16 v[40:43], v[112:113], v[32:33], v[40:43]
  v_mfma_f32_16x16x16_bf16 v[44:47], v[114:115], v[32:33], v[44:47]
  buffer_load_dwordx4 v[112:115], v2, s[36:39], s48 offen offset:0 nt
  v_mov_b32_dpp v36, v51 row_ror:8 row_mask:0xf bank_mask:0x1
  v_mov_b32_dpp v36, v52 row_ror:12 row_mask:0xf bank_mask:0x2
  v_mov_b32_dpp v37, v51 quad_perm:[0,1,2,3] row_mask:0xf bank_mask:0x4
  v_mov_b32_dpp v37, v52 row_ror:4 row_mask:0xf bank_mask:0x8
  s_waitcnt vmcnt(9)
  v_mfma_f32_16x16x16_bf16 v[40:43], v[116:117], v[34:35], v[40:43]
  v_mfma_f32_16x16x16_bf16 v[44:47], v[118:119], v[34:35], v[44:47]
  buffer_load_dwordx4 v[116:119], v2, s[36:39], s48 offen offset:1024 nt
  v_mov_b32_dpp v38, v51 row_ror:4 row_mask:0xf bank_mask:0x1
  v_mov_b32_dpp v38, v52 row_ror:8 row_mask:0xf bank_mask:0x2
  v_mov_b32_dpp v39, v51 row_ror:12 row_mask:0xf bank_mask:0x4
  v_mov_b32_dpp v39, v52 quad_perm:[0,1,2,3] row_mask:0xf bank_mask:0x8
  s_waitcnt vmcnt(9)
  v_mfma_f32_16x16x16_bf16 v[40:43], v[120:121], v[36:37], v[40:43]
  v_mfma_f32_16x16x16_bf16 v[44:47], v[122:123], v[36:37], v[44:47]
  buffer_load_dwordx4 v[120:123], v2, s[36:39], s48 offen offset:2048 nt
  s_waitcnt vmcnt(9)
  v_mfma_f32_16x16x16_bf16 v[40:43], v[124:125], v[38:39], v[40:43]
  v_mfma_f32_16x16x16_bf16 v[44:47], v[126:127], v[38:39], v[44:47]
  buffer_load_dwordx4 v[124:127], v2, s[36:39], s48 offen offset:3072 nt
  s_sub_u32 s60, s60, 1
  s_cmp_lg_u32 s60, 0
  s_cbranch_scc1 L_pace
L_pairx:
  s_add_u32 s48, s48, 65536
  s_waitcnt vmcnt(6)
  v_mfma_f32_16x16x32_bf16 v[16:19], v[64:67], v[12:15], 0
  buffer_load_dwordx4 v[64:67], v1, s[32:35], s48 offen offset:0 nt
  s_waitcnt vmcnt(6)
  v_mfma_f32_16x16x32_bf16 v[20:23], v[68:71], v[12:15], 0
  buffer_load_dwordx4 v[68:71], v1, s[32:35], s48 offen offset:1024 nt
  s_waitcnt vmcnt(6)
  v_mfma_f32_16x16x32_bf16 v[24:27], v[72:75], v[12:15], 0
  buffer_load_dwordx4 v[72:75], v1, s[32:35], s48 offen offset:2048 nt
  s_waitcnt vmcnt(6)
  v_mfma_f32_16x16x32_bf16 v[28:31], v[76:79], v[12:15], 0
  buffer_load_dwordx4 v[76:79], v1, s[32:35], s48 offen offset:3072 nt
  s_nop 4
  v_add_f32_dpp v48, v17, v16 row_ror:12 row_mask:0xf bank_mask:0x1
  v_add_f32_dpp v48, v18, v48 row_ror:8 row_mask:0xf bank_mask:0x1
  v_add_f32_dpp v48, v19, v48 row_ror:4 row_mask:0xf bank_mask:0x1
  v_add_f32_dpp v48, v22, v21 row_ror:12 row_mask:0xf bank_mask:0x2
  v_add_f32_dpp v48, v23, v48 row_ror:8 row_mask:0xf bank_mask:0x2
  v_add_f32_dpp v48, v20, v48 row_ror:4 row_mask:0xf bank_mask:0x2
  v_add_f32_dpp v48, v27, v26 row_ror:12 row_mask:0xf bank_mask:0x4
  v_add_f32_dpp v48, v24, v48 row_ror:8 row_mask:0xf bank_mask:0x4
  v_add_f32_dpp v48, v25, v48 row_ror:4 row_mask:0xf bank_mask:0x4
  v_add_f32_dpp v48, v28, v31 row_ror:12 row_mask:0xf bank_mask:0x8
  v_add_f32_dpp v48, v29, v48 row_ror:8 row_mask:0xf bank_mask:0x8
  v_add_f32_dpp v48, v30, v48 row_ror:4 row_mask:0xf bank_mask:0x8
  v_cvt_pk_bf16_f32 v48, 0, v48
  v_mul_f32 v48, s57, v48
  v_cvt_pk_bf16_f32 v48, 0, v48
  v_mul_f32 v49, s59, v48
  v_cmp_gt_f32 vcc, v49, v54
  s_cbranch_vccz L_nors18
  v_max_f32_dpp v49, v49, v49 row_ror:4 row_mask:0xf bank_mask:0xf
  s_nop 1
  v_max_f32_dpp v49, v49, v49 row_ror:8 row_mask:0xf bank_mask:0xf
  v_mov_b32 v50, v49
  s_nop 1
  v_permlane16_swap_b32 v49, v50
  v_max_f32 v49, v49, v50
  v_mov_b32 v50, v49
  s_nop 1
  v_permlane32_swap_b32 v49, v50
  v_max_f32 v49, v49, v50
  v_max_f32 v49, v49, v54
  v_sub_f32 v56, v54, v49
  v_exp_f32 v56, v56
  v_mov_b32 v54, v49
  v_mul_f32 v55, v55, v56
  v_mul_f32 v40, v40, v56
  v_mul_f32 v41, v41, v56
  v_mul_f32 v42, v42, v56
  v_mul_f32 v43, v43, v56
  v_mul_f32 v44, v44, v56
  v_mul_f32 v45, v45, v56
  v_mul_f32 v46, v46, v56
  v_mul_f32 v47, v47, v56
L_nors18:
  v_fma_f32 v48, v48, s59, -v54
  v_exp_f32 v48, v48
  s_nop 0
  v_cvt_pk_bf16_f32 v51, v48, 0
  v_cvt_pk_bf16_f32 v52, 0, v48
  v_add_f32 v55, v55, v48
  v_mov_b32_dpp v32, v51 quad_perm:[0,1,2,3] row_mask:0xf bank_mask:0x1
  v_mov_b32_dpp v32, v52 row_ror:4 row_mask:0xf bank_mask:0x2
  v_mov_b32_dpp v33, v51 row_ror:8 row_mask:0xf bank_mask:0x4
  v_mov_b32_dpp v33, v52 row_ror:12 row_mask:0xf bank_mask:0x8
  v_mov_b32_dpp v34, v51 row_ror:12 row_mask:0xf bank_mask:0x1
  v_mov_b32_dpp v34, v52 quad_perm:[0,1,2,3] row_mask:0xf bank_mask:0x2
  v_mov_b32_dpp v35, v51 row_ror:4 row_mask:0xf bank_mask:0x4
  v_mov_b32_dpp v35, v52 row_ror:8 row_mask:0xf bank_mask:0x8
  s_waitcnt vmcnt(6)
  v_mfma_f32_16x16x16_bf16 v[40:43], v[80:81], v[32:33], v[40:43]
  v_mfma_f32_16x16x16_bf16 v[44:47], v[82:83], v[32:33], v[44:47]
  buffer_load_dwordx4 v[80:83], v2, s[36:39], s48 offen offset:0 nt
  v_mov_b32_dpp v36, v51 row_ror:8 row_mask:0xf bank_mask:0x1
  v_mov_b32_dpp v36, v52 row_ror:12 row_mask:0xf bank_mask:0x2
  v_mov_b32_dpp v37, v51 quad_perm:[0,1,2,3] row_mask:0xf bank_mask:0x4
  v_mov_b32_dpp v37, v52 row_ror:4 row_mask:0xf bank_mask:0x8
  s_waitcnt vmcnt(6)
  v_mfma_f32_16x16x16_bf16 v[40:43], v[84:85], v[34:35], v[40:43]
  v_mfma_f32_16x16x16_bf16 v[44:47], v[86:87], v[34:35], v[44:47]
  buffer_load_dwordx4 v[84:87], v2, s[36:39], s48 offen offset:1024 nt
  v_mov_b32_dpp v38, v51 row_ror:4 row_mask:0xf bank_mask:0x1
  v_mov_b32_dpp v38, v52 row_ror:8 row_mask:0xf bank_mask:0x2
  v_mov_b32_dpp v39, v51 row_ror:12 row_mask:0xf bank_mask:0x4
  v_mov_b32_dpp v39, v52 quad_perm:[0,1,2,3] row_mask:0xf bank_mask:0x8
  s_waitcnt vmcnt(6)
  v_mfma_f32_16x16x16_bf16 v[40:43], v[88:89], v[36:37], v[40:43]
  v_mfma_f32_16x16x16_bf16 v[44:47], v[90:91], v[36:37], v[44:47]
  buffer_load_dwordx4 v[88:91], v2, s[36:39], s48 offen offset:2048 nt
  s_waitcnt vmcnt(6)
  v_mfma_f32_16x16x16_bf16 v[40:43], v[92:93], v[38:39], v[40:43]
  v_mfma_f32_16x16x16_bf16 v[44:47], v[94:95], v[38:39], v[44:47]
  buffer_load_dwordx4 v[92:95], v2, s[36:39], s48 offen offset:3072 nt
  s_waitcnt vmcnt(15)
  v_mfma_f32_16x16x32_bf16 v[16:19], v[96:99], v[12:15], 0
  s_waitcnt vmcnt(14)
  v_mfma_f32_16x16x32_bf16 v[20:23], v[100:103], v[12:15], 0
  s_waitcnt vmcnt(13)
  v_mfma_f32_16x16x32_bf16 v[24:27], v[104:107], v[12:15], 0
  s_waitcnt vmcnt(12)
  v_mfma_f32_16x16x32_bf16 v[28:31], v[108:111], v[12:15], 0
  s_nop 4
  v_add_f32_dpp v48, v17, v16 row_ror:12 row_mask:0xf bank_mask:0x1
  v_add_f32_dpp v48, v18, v48 row_ror:8 row_mask:0xf bank_mask:0x1
  v_add_f32_dpp v48, v19, v48 row_ror:4 row_mask:0xf bank_mask:0x1
  v_add_f32_dpp v48, v22, v21 row_ror:12 row_mask:0xf bank_mask:0x2
  v_add_f32_dpp v48, v23, v48 row_ror:8 row_mask:0xf bank_mask:0x2
  v_add_f32_dpp v48, v20, v48 row_ror:4 row_mask:0xf bank_mask:0x2
  v_add_f32_dpp v48, v27, v26 row_ror:12 row_mask:0xf bank_mask:0x4
  v_add_f32_dpp v48, v24, v48 row_ror:8 row_mask:0xf bank_mask:0x4
  v_add_f32_dpp v48, v25, v48 row_ror:4 row_mask:0xf bank_mask:0x4
  v_add_f32_dpp v48, v28, v31 row_ror:12 row_mask:0xf bank_mask:0x8
  v_add_f32_dpp v48, v29, v48 row_ror:8 row_mask:0xf bank_mask:0x8
  v_add_f32_dpp v48, v30, v48 row_ror:4 row_mask:0xf bank_mask:0x8
  v_cvt_pk_bf16_f32 v48, 0, v48
  v_mul_f32 v48, s57, v48
  v_cvt_pk_bf16_f32 v48, 0, v48
  v_mul_f32 v49, s59, v48
  v_cmp_gt_f32 vcc, v49, v54
  s_cbranch_vccz L_nors19
  v_max_f32_dpp v49, v49, v49 row_ror:4 row_mask:0xf bank_mask:0xf
  s_nop 1
  v_max_f32_dpp v49, v49, v49 row_ror:8 row_mask:0xf bank_mask:0xf
  v_mov_b32 v50, v49
  s_nop 1
  v_permlane16_swap_b32 v49, v50
  v_max_f32 v49, v49, v50
  v_mov_b32 v50, v49
  s_nop 1
  v_permlane32_swap_b32 v49, v50
  v_max_f32 v49, v49, v50
  v_max_f32 v49, v49, v54
  v_sub_f32 v56, v54, v49
  v_exp_f32 v56, v56
  v_mov_b32 v54, v49
  v_mul_f32 v55, v55, v56
  v_mul_f32 v40, v40, v56
  v_mul_f32 v41, v41, v56
  v_mul_f32 v42, v42, v56
  v_mul_f32 v43, v43, v56
  v_mul_f32 v44, v44, v56
  v_mul_f32 v45, v45, v56
  v_mul_f32 v46, v46, v56
  v_mul_f32 v47, v47, v56
L_nors19:
  v_fma_f32 v48, v48, s59, -v54
  v_exp_f32 v48, v48
  s_nop 0
  v_cvt_pk_bf16_f32 v51, v48, 0
  v_cvt_pk_bf16_f32 v52, 0, v48
  v_add_f32 v55, v55, v48
  v_mov_b32_dpp v32, v51 quad_perm:[0,1,2,3] row_mask:0xf bank_mask:0x1
  v_mov_b32_dpp v32, v52 row_ror:4 row_mask:0xf bank_mask:0x2
  v_mov_b32_dpp v33, v51 row_ror:8 row_mask:0xf bank_mask:0x4
  v_mov_b32_dpp v33, v52 row_ror:12 row_mask:0xf bank_mask:0x8
  v_mov_b32_dpp v34, v51 row_ror:12 row_mask:0xf bank_mask:0x1
  v_mov_b32_dpp v34, v52 quad_perm:[0,1,2,3] row_mask:0xf bank_mask:0x2
  v_mov_b32_dpp v35, v51 row_ror:4 row_mask:0xf bank_mask:0x4
  v_mov_b32_dpp v35, v52 row_ror:8 row_mask:0xf bank_mask:0x8
  s_waitcnt vmcnt(11)
  v_mfma_f32_16x16x16_bf16 v[40:43], v[112:113], v[32:33], v[40:43]
  v_mfma_f32_16x16x16_bf16 v[44:47], v[114:115], v[32:33], v[44:47]
  v_mov_b32_dpp v36, v51 row_ror:8 row_mask:0xf bank_mask:0x1
  v_mov_b32_dpp v36, v52 row_ror:12 row_mask:0xf bank_mask:0x2
  v_mov_b32_dpp v37, v51 quad_perm:[0,1,2,3] row_mask:0xf bank_mask:0x4
  v_mov_b32_dpp v37, v52 row_ror:4 row_mask:0xf bank_mask:0x8
  s_waitcnt vmcnt(10)
  v_mfma_f32_16x16x16_bf16 v[40:43], v[116:117], v[34:35], v[40:43]
  v_mfma_f32_16x16x16_bf16 v[44:47], v[118:119], v[34:35], v[44:47]
  v_mov_b32_dpp v38, v51 row_ror:4 row_mask:0xf bank_mask:0x1
  v_mov_b32_dpp v38, v52 row_ror:8 row_mask:0xf bank_mask:0x2
  v_mov_b32_dpp v39, v51 row_ror:12 row_mask:0xf bank_mask:0x4
  v_mov_b32_dpp v39, v52 quad_perm:[0,1,2,3] row_mask:0xf bank_mask:0x8
  s_waitcnt vmcnt(9)
  v_mfma_f32_16x16x16_bf16 v[40:43], v[120:121], v[36:37], v[40:43]
  v_mfma_f32_16x16x16_bf16 v[44:47], v[122:123], v[36:37], v[44:47]
  s_waitcnt vmcnt(8)
  v_mfma_f32_16x16x16_bf16 v[40:43], v[124:125], v[38:39], v[40:43]
  v_mfma_f32_16x16x16_bf16 v[44:47], v[126:127], v[38:39], v[44:47]
  s_mov_b32 s60, 28
L_loop:
  s_add_u32 s60, s60, 1
  s_cmp_lt_u32 s60, 30
  s_cbranch_scc0 L_dyn
  s_add_u32 s48, s48, 65536
  s_cmp_lt_u32 s60, 29
  s_cbranch_scc1 L_body
  s_branch L_claim
L_dyn:
  s_waitcnt vmcnt(8)
L_tk:
  v_readfirstlane_b32 s61, v57
  s_bitcmp1_b32 s61, 0
  s_cbranch_scc0 L_tkwait
  s_cmp_lt_u32 s61, 80
  s_cbranch_scc0 L_last
  s_lshr_b32 s58, s61, 3
  s_lshl_b32 s58, s58, 16
  s_bfe_u32 s48, s61, 0x20001
  s_lshl_b32 s48, s48, 12
  s_add_u32 s48, s48, s58
  s_add_u32 s48, s48, s55
  s_cmp_lt_u32 s61, 16
  s_cbranch_scc1 L_claim
  s_add_u32 s61, s61, 943
  s_lshl_b32 s61, s61, 11
  s_add_u32 s48, s56, s61
L_claim:
  v_mov_b32 v57, 2
  s_mov_b64 exec, 1
  buffer_atomic_add v57, v9, s[28:31], s52 offen sc0 sc1
  s_mov_b64 exec, -1
L_body:
  s_waitcnt vmcnt(7)
  v_mfma_f32_16x16x32_bf16 v[16:19], v[64:67], v[12:15], 0
  buffer_load_dwordx4 v[64:67], v1, s[32:35], s48 offen offset:0 nt
  s_waitcnt vmcnt(7)
  v_mfma_f32_16x16x32_bf16 v[20:23], v[68:71], v[12:15], 0
  buffer_load_dwordx4 v[68:71], v1, s[32:35], s48 offen offset:1024 nt
  s_waitcnt vmcnt(7)
  v_mfma_f32_16x16x32_bf16 v[24:27], v[72:75], v[12:15], 0
  buffer_load_dwordx4 v[72:75], v1, s[32:35], s48 offen offset:2048 nt
  s_waitcnt vmcnt(7)
  v_mfma_f32_16x16x32_bf16 v[28:31], v[76:79], v[12:15], 0
  buffer_load_dwordx4 v[76:79], v1, s[32:35], s48 offen offset:3072 nt
  s_nop 4
  v_add_f32_dpp v48, v17, v16 row_ror:12 row_mask:0xf bank_mask:0x1
  v_add_f32_dpp v48, v18, v48 row_ror:8 row_mask:0xf bank_mask:0x1
  v_add_f32_dpp v48, v19, v48 row_ror:4 row_mask:0xf bank_mask:0x1
  v_add_f32_dpp v48, v22, v21 row_ror:12 row_mask:0xf bank_mask:0x2
  v_add_f32_dpp v48, v23, v48 row_ror:8 row_mask:0xf bank_mask:0x2
  v_add_f32_dpp v48, v20, v48 row_ror:4 row_mask:0xf bank_mask:0x2
  v_add_f32_dpp v48, v27, v26 row_ror:12 row_mask:0xf bank_mask:0x4
  v_add_f32_dpp v48, v24, v48 row_ror:8 row_mask:0xf bank_mask:0x4
  v_add_f32_dpp v48, v25, v48 row_ror:4 row_mask:0xf bank_mask:0x4
  v_add_f32_dpp v48, v28, v31 row_ror:12 row_mask:0xf bank_mask:0x8
  v_add_f32_dpp v48, v29, v48 row_ror:8 row_mask:0xf bank_mask:0x8
  v_add_f32_dpp v48, v30, v48 row_ror:4 row_mask:0xf bank_mask:0x8
  v_cvt_pk_bf16_f32 v48, 0, v48
  v_mul_f32 v48, s57, v48
  v_cvt_pk_bf16_f32 v48, 0, v48
  v_mul_f32 v49, s59, v48
  v_cmp_gt_f32 vcc, v49, v54
  s_cbranch_vccz L_nors20
  v_max_f32_dpp v49, v49, v49 row_ror:4 row_mask:0xf bank_mask:0xf
  s_nop 1
  v_max_f32_dpp v49, v49, v49 row_ror:8 row_mask:0xf bank_mask:0xf
  v_mov_b32 v50, v49
  s_nop 1
  v_permlane16_swap_b32 v49, v50
  v_max_f32 v49, v49, v50
  v_mov_b32 v50, v49
  s_nop 1
  v_permlane32_swap_b32 v49, v50
  v_max_f32 v49, v49, v50
  v_max_f32 v49, v49, v54
  v_sub_f32 v56, v54, v49
  v_exp_f32 v56, v56
  v_mov_b32 v54, v49
  v_mul_f32 v55, v55, v56
  v_mul_f32 v40, v40, v56
  v_mul_f32 v41, v41, v56
  v_mul_f32 v42, v42, v56
  v_mul_f32 v43, v43, v56
  v_mul_f32 v44, v44, v56
  v_mul_f32 v45, v45, v56
  v_mul_f32 v46, v46, v56
  v_mul_f32 v47, v47, v56
L_nors20:
  v_fma_f32 v48, v48, s59, -v54
  v_exp_f32 v48, v48
  s_nop 0
  v_cvt_pk_bf16_f32 v51, v48, 0
  v_cvt_pk_bf16_f32 v52, 0, v48
  v_add_f32 v55, v55, v48
  v_mov_b32_dpp v32, v51 quad_perm:[0,1,2,3] row_mask:0xf bank_mask:0x1
  v_mov_b32_dpp v32, v52 row_ror:4 row_mask:0xf bank_mask:0x2
  v_mov_b32_dpp v33, v51 row_ror:8 row_mask:0xf bank_mask:0x4
  v_mov_b32_dpp v33, v52 row_ror:12 row_mask:0xf bank_mask:0x8
  v_mov_b32_dpp v34, v51 row_ror:12 row_mask:0xf bank_mask:0x1
  v_mov_b32_dpp v34, v52 quad_perm:[0,1,2,3] row_mask:0xf bank_mask:0x2
  v_mov_b32_dpp v35, v51 row_ror:4 row_mask:0xf bank_mask:0x4
  v_mov_b32_dpp v35, v52 row_ror:8 row_mask:0xf bank_mask:0x8
  s_waitcnt vmcnt(7)
  v_mfma_f32_16x16x16_bf16 v[40:43], v[80:81], v[32:33], v[40:43]
  v_mfma_f32_16x16x16_bf16 v[44:47], v[82:83], v[32:33], v[44:47]
  buffer_load_dwordx4 v[80:83], v2, s[36:39], s48 offen offset:0 nt
  v_mov_b32_dpp v36, v51 row_ror:8 row_mask:0xf bank_mask:0x1
  v_mov_b32_dpp v36, v52 row_ror:12 row_mask:0xf bank_mask:0x2
  v_mov_b32_dpp v37, v51 quad_perm:[0,1,2,3] row_mask:0xf bank_mask:0x4
  v_mov_b32_dpp v37, v52 row_ror:4 row_mask:0xf bank_mask:0x8
  s_waitcnt vmcnt(7)
  v_mfma_f32_16x16x16_bf16 v[40:43], v[84:85], v[34:35], v[40:43]
  v_mfma_f32_16x16x16_bf16 v[44:47], v[86:87], v[34:35], v[44:47]
  buffer_load_dwordx4 v[84:87], v2, s[36:39], s48 offen offset:1024 nt
  v_mov_b32_dpp v38, v51 row_ror:4 row_mask:0xf bank_mask:0x1
  v_mov_b32_dpp v38, v52 row_ror:8 row_mask:0xf bank_mask:0x2
  v_mov_b32_dpp v39, v51 row_ror:12 row_mask:0xf bank_mask:0x4
  v_mov_b32_dpp v39, v52 quad_perm:[0,1,2,3] row_mask:0xf bank_mask:0x8
  s_waitcnt vmcnt(7)
  v_mfma_f32_16x16x16_bf16 v[40:43], v[88:89], v[36:37], v[40:43]
  v_mfma_f32_16x16x16_bf16 v[44:47], v[90:91], v[36:37], v[44:47]
  buffer_load_dwordx4 v[88:91], v2, s[36:39], s48 offen offset:2048 nt
  s_waitcnt vmcnt(7)
  v_mfma_f32_16x16x16_bf16 v[40:43], v[92:93], v[38:39], v[40:43]
  v_mfma_f32_16x16x16_bf16 v[44:47], v[94:95], v[38:39], v[44:47]
  buffer_load_dwordx4 v[92:95], v2, s[36:39], s48 offen offset:3072 nt
  s_branch L_loop
L_last:
  s_mov_b64 exec, 1
  v_mov_b32 v10, 1
  ds_add_u32 v9, v10 offset:1036
  s_mov_b64 exec, -1
  s_waitcnt vmcnt(7)
  v_mfma_f32_16x16x32_bf16 v[16:19], v[64:67], v[12:15], 0
  s_waitcnt vmcnt(6)
  v_mfma_f32_16x16x32_bf16 v[20:23], v[68:71], v[12:15], 0
  s_waitcnt vmcnt(5)
  v_mfma_f32_16x16x32_bf16 v[24:27], v[72:75], v[12:15], 0
  s_waitcnt vmcnt(4)
  v_mfma_f32_16x16x32_bf16 v[28:31], v[76:79], v[12:15], 0
  s_nop 4
  v_add_f32_dpp v48, v17, v16 row_ror:12 row_mask:0xf bank_mask:0x1
  v_add_f32_dpp v48, v18, v48 row_ror:8 row_mask:0xf bank_mask:0x1
  v_add_f32_dpp v48, v19, v48 row_ror:4 row_mask:0xf bank_mask:0x1
  v_add_f32_dpp v48, v22, v21 row_ror:12 row_mask:0xf bank_mask:0x2
  v_add_f32_dpp v48, v23, v48 row_ror:8 row_mask:0xf bank_mask:0x2
  v_add_f32_dpp v48, v20, v48 row_ror:4 row_mask:0xf bank_mask:0x2
  v_add_f32_dpp v48, v27, v26 row_ror:12 row_mask:0xf bank_mask:0x4
  v_add_f32_dpp v48, v24, v48 row_ror:8 row_mask:0xf bank_mask:0x4
  v_add_f32_dpp v48, v25, v48 row_ror:4 row_mask:0xf bank_mask:0x4
  v_add_f32_dpp v48, v28, v31 row_ror:12 row_mask:0xf bank_mask:0x8
  v_add_f32_dpp v48, v29, v48 row_ror:8 row_mask:0xf bank_mask:0x8
  v_add_f32_dpp v48, v30, v48 row_ror:4 row_mask:0xf bank_mask:0x8
  v_cvt_pk_bf16_f32 v48, 0, v48
  v_mul_f32 v48, s57, v48
  v_cvt_pk_bf16_f32 v48, 0, v48
  v_mul_f32 v49, s59, v48
  v_cmp_gt_f32 vcc, v49, v54
  s_cbranch_vccz L_nors21
  v_max_f32_dpp v49, v49, v49 row_ror:4 row_mask:0xf bank_mask:0xf
  s_nop 1
  v_max_f32_dpp v49, v49, v49 row_ror:8 row_mask:0xf bank_mask:0xf
  v_mov_b32 v50, v49
  s_nop 1
  v_permlane16_swap_b32 v49, v50
  v_max_f32 v49, v49, v50
  v_mov_b32 v50, v49
  s_nop 1
  v_permlane32_swap_b32 v49, v50
  v_max_f32 v49, v49, v50
  v_max_f32 v49, v49, v54
  v_sub_f32 v56, v54, v49
  v_exp_f32 v56, v56
  v_mov_b32 v54, v49
  v_mul_f32 v55, v55, v56
  v_mul_f32 v40, v40, v56
  v_mul_f32 v41, v41, v56
  v_mul_f32 v42, v42, v56
  v_mul_f32 v43, v43, v56
  v_mul_f32 v44, v44, v56
  v_mul_f32 v45, v45, v56
  v_mul_f32 v46, v46, v56
  v_mul_f32 v47, v47, v56
L_nors21:
  v_fma_f32 v48, v48, s59, -v54
  v_exp_f32 v48, v48
  s_nop 0
  v_cvt_pk_bf16_f32 v51, v48, 0
  v_cvt_pk_bf16_f32 v52, 0, v48
  v_add_f32 v55, v55, v48
  v_mov_b32_dpp v32, v51 quad_perm:[0,1,2,3] row_mask:0xf bank_mask:0x1
  v_mov_b32_dpp v32, v52 row_ror:4 row_mask:0xf bank_mask:0x2
  v_mov_b32_dpp v33, v51 row_ror:8 row_mask:0xf bank_mask:0x4
  v_mov_b32_dpp v33, v52 row_ror:12 row_mask:0xf bank_mask:0x8
  v_mov_b32_dpp v34, v51 row_ror:12 row_mask:0xf bank_mask:0x1
  v_mov_b32_dpp v34, v52 quad_perm:[0,1,2,3] row_mask:0xf bank_mask:0x2
  v_mov_b32_dpp v35, v51 row_ror:4 row_mask:0xf bank_mask:0x4
  v_mov_b32_dpp v35, v52 row_ror:8 row_mask:0xf bank_mask:0x8
  s_waitcnt vmcnt(3)
  v_mfma_f32_16x16x16_bf16 v[40:43], v[80:81], v[32:33], v[40:43]
  v_mfma_f32_16x16x16_bf16 v[44:47], v[82:83], v[32:33], v[44:47]
  v_mov_b32_dpp v36, v51 row_ror:8 row_mask:0xf bank_mask:0x1
  v_mov_b32_dpp v36, v52 row_ror:12 row_mask:0xf bank_mask:0x2
  v_mov_b32_dpp v37, v51 quad_perm:[0,1,2,3] row_mask:0xf bank_mask:0x4
  v_mov_b32_dpp v37, v52 row_ror:4 row_mask:0xf bank_mask:0x8
  s_waitcnt vmcnt(2)
  v_mfma_f32_16x16x16_bf16 v[40:43], v[84:85], v[34:35], v[40:43]
  v_mfma_f32_16x16x16_bf16 v[44:47], v[86:87], v[34:35], v[44:47]
  v_mov_b32_dpp v38, v51 row_ror:4 row_mask:0xf bank_mask:0x1
  v_mov_b32_dpp v38, v52 row_ror:8 row_mask:0xf bank_mask:0x2
  v_mov_b32_dpp v39, v51 row_ror:12 row_mask:0xf bank_mask:0x4
  v_mov_b32_dpp v39, v52 quad_perm:[0,1,2,3] row_mask:0xf bank_mask:0x8
  s_waitcnt vmcnt(1)
  v_mfma_f32_16x16x16_bf16 v[40:43], v[88:89], v[36:37], v[40:43]
  v_mfma_f32_16x16x16_bf16 v[44:47], v[90:91], v[36:37], v[44:47]
  s_waitcnt vmcnt(0)
  v_mfma_f32_16x16x16_bf16 v[40:43], v[92:93], v[38:39], v[40:43]
  v_mfma_f32_16x16x16_bf16 v[44:47], v[94:95], v[38:39], v[44:47]
  s_nop 0
  v_add_f32_dpp v55, v55, v55 row_ror:4 row_mask:0xf bank_mask:0xf
  s_nop 1
  v_add_f32_dpp v55, v55, v55 row_ror:8 row_mask:0xf bank_mask:0xf
  v_mov_b32 v50, v55
  s_nop 1
  v_permlane16_swap_b32 v55, v50
  v_add_f32 v55, v55, v50
  v_mov_b32 v50, v55
  s_nop 1
  v_permlane32_swap_b32 v55, v50
  v_add_f32 v55, v55, v50
  ds_write_b64 v61, v[54:55] offset:4096
  ds_write_b128 v60, v[40:43] offset:2048
  ds_write_b128 v60, v[44:47] offset:3072
  s_waitcnt lgkmcnt(0)
  s_barrier
  s_cmp_eq_u32 s44, 0
  s_cbranch_scc0 L_s13
  ds_read_b64 v[16:17], v63 offset:4096
  ds_read_b64 v[18:19], v63 offset:6656
  ds_read_b64 v[20:21], v63 offset:9216
  ds_read_b64 v[22:23], v63 offset:11776
  ds_read_b128 v[64:67], v62 offset:2048
  ds_read_b128 v[68:71], v62 offset:3072
  ds_read_b128 v[72:75], v62 offset:4608
  ds_read_b128 v[76:79], v62 offset:5632
  ds_read_b128 v[80:83], v62 offset:7168
  ds_read_b128 v[84:87], v62 offset:8192
  ds_read_b128 v[88:91], v62 offset:9728
  ds_read_b128 v[92:95], v62 offset:10752
  s_waitcnt lgkmcnt(8)
  v_max3_f32 v24, v16, v18, v20
  v_max_f32 v24, v24, v22
  v_sub_f32 v16, v16, v24
  v_sub_f32 v18, v18, v24
  v_sub_f32 v20, v20, v24
  v_sub_f32 v22, v22, v24
  v_exp_f32 v16, v16
  v_exp_f32 v18, v18
  v_exp_f32 v20, v20
  v_exp_f32 v22, v22
  s_nop 0
  v_mul_f32 v25, v16, v17
  v_mul_f32 v27, v20, v21
  v_fmac_f32 v25, v18, v19
  v_fmac_f32 v27, v22, v23
  v_add_f32 v25, v25, v27
  v_rcp_f32 v26, v25
  v_log_f32 v42, v25
  s_waitcnt lgkmcnt(0)
  v_pk_mul_f32 v[64:65], v[64:65], v[16:17] op_sel_hi:[1,0]
  v_pk_mul_f32 v[66:67], v[66:67], v[16:17] op_sel_hi:[1,0]
  v_pk_mul_f32 v[68:69], v[68:69], v[16:17] op_sel_hi:[1,0]
  v_pk_mul_f32 v[70:71], v[70:71], v[16:17] op_sel_hi:[1,0]
  v_pk_fma_f32 v[64:65], v[72:73], v[18:19], v[64:65] op_sel_hi:[1,0,1]
  v_pk_fma_f32 v[66:67], v[74:75], v[18:19], v[66:67] op_sel_hi:[1,0,1]
  v_pk_fma_f32 v[68:69], v[76:77], v[18:19], v[68:69] op_sel_hi:[1,0,1]
  v_pk_fma_f32 v[70:71], v[78:79], v[18:19], v[70:71] op_sel_hi:[1,0,1]
  v_pk_fma_f32 v[64:65], v[80:81], v[20:21], v[64:65] op_sel_hi:[1,0,1]
  v_pk_fma_f32 v[66:67], v[82:83], v[20:21], v[66:67] op_sel_hi:[1,0,1]
  v_pk_fma_f32 v[68:69], v[84:85], v[20:21], v[68:69] op_sel_hi:[1,0,1]
  v_pk_fma_f32 v[70:71], v[86:87], v[20:21], v[70:71] op_sel_hi:[1,0,1]
  v_pk_fma_f32 v[64:65], v[88:89], v[22:23], v[64:65] op_sel_hi:[1,0,1]
  v_pk_fma_f32 v[66:67], v[90:91], v[22:23], v[66:67] op_sel_hi:[1,0,1]
  v_pk_fma_f32 v[68:69], v[92:93], v[22:23], v[68:69] op_sel_hi:[1,0,1]
  v_pk_fma_f32 v[70:71], v[94:95], v[22:23], v[70:71] op_sel_hi:[1,0,1]
  v_add_f32 v42, v42, v24
  v_pk_mul_f32 v[64:65], v[64:65], v[26:27] op_sel_hi:[1,0]
  v_pk_mul_f32 v[66:67], v[66:67], v[26:27] op_sel_hi:[1,0]
  v_pk_mul_f32 v[68:69], v[68:69], v[26:27] op_sel_hi:[1,0]
  v_pk_mul_f32 v[70:71], v[70:71], v[26:27] op_sel_hi:[1,0]
  v_mov_b32 v46, v42
  v_xor_b32 v29, s89, v42
  v_cvt_pk_bf16_f32 v40, v64, v68
  v_cvt_pk_bf16_f32 v41, v65, v69
  v_cvt_pk_bf16_f32 v44, v66, v70
  v_cvt_pk_bf16_f32 v45, v67, v71
  v_bitop3_b32 v43, v40, v41, v29 bitop3:0x96
  v_bitop3_b32 v47, v44, v45, v29 bitop3:0x96
  buffer_store_dwordx4 v[40:43], v59, s[28:31], s86 offen sc1
  buffer_store_dwordx4 v[44:47], v59, s[28:31], s86 offen offset:256 sc1
  s_barrier
  s_branch L_fin
L_tkwait:
  s_waitcnt vmcnt(0)
  v_or_b32 v57, 1, v57
  s_nop 0
  s_branch L_tk
L_s13:
  s_cmp_eq_u32 s44, 1
  s_cbranch_scc0 L_fin
  s_mov_b32 s40, s14
  s_mov_b32 s41, s15
  s_mov_b32 s42, 0x2000
  s_mov_b32 s43, 0x20000
  s_and_b32 s88, s2, 7
  s_bfe_u32 s87, s2, 0x30003
  s_lshl3_add_u32 s88, s88, s87
  s_lshr_b32 s87, s2, 6
  s_lshl_b32 s86, s87, 6
  s_add_u32 s86, s86, s88
  s_bfe_u32 s64, s86, 0x10001
  s_bfe_u32 s65, s86, 0x10005
  s_andn2_b32 s86, s86, 0x22
  s_lshl_b32 s64, s64, 5
  s_add_u32 s86, s86, s64
  s_lshl1_add_u32 s86, s65, s86
  s_lshl_b32 s86, s86, 12
  s_xor_b32 s86, s86, s91
  s_add_u32 s86, s86, 1048576
  s_lshl_b32 s87, s87, 11
  s_lshl4_add_u32 s87, s88, s87
  v_and_b32 v11, 7, v0
  v_lshlrev_b32 v11, 1, v11
  v_lshl_add_u32 v11, v3, 10, v11
  s_mov_b32 s88, 0
  s_barrier
  s_barrier
  s_cmp_eq_u32 s2, 0
  s_cbranch_scc0 L_noep
  s_mov_b64 exec, 1
  v_mov_b32 v17, s89
  buffer_store_dword v17, v9, s[28:31], 0 offen sc1
  s_mov_b64 exec, -1
L_noep:
  s_sleep 18
L_h2poll:
  buffer_load_dwordx4 v[16:19], v2, s[28:31], s86 offen offset:0 sc1
  buffer_load_dwordx4 v[20:23], v2, s[28:31], s86 offen offset:1024 sc1
  buffer_load_dwordx4 v[24:27], v2, s[28:31], s86 offen offset:2048 sc1
  buffer_load_dwordx4 v[28:31], v2, s[28:31], s86 offen offset:3072 sc1
  s_waitcnt vmcnt(3)
  v_bitop3_b32 v32, v16, v18, s89 bitop3:0x96
  v_bitop3_b32 v33, v17, v19, s89 bitop3:0x96
  s_waitcnt vmcnt(2)
  v_bitop3_b32 v34, v20, v22, s89 bitop3:0x96
  v_bitop3_b32 v35, v21, v23, s89 bitop3:0x96
  v_or3_b32 v32, v32, v33, v34
  s_waitcnt vmcnt(1)
  v_bitop3_b32 v36, v24, v26, s89 bitop3:0x96
  v_bitop3_b32 v37, v25, v27, s89 bitop3:0x96
  v_or3_b32 v35, v35, v36, v37
  s_waitcnt vmcnt(0)
  v_bitop3_b32 v38, v28, v30, s89 bitop3:0x96
  v_bitop3_b32 v39, v29, v31, s89 bitop3:0x96
  v_or3_b32 v32, v32, v38, v39
  v_or_b32 v32, v32, v35
  v_cmp_ne_u32 vcc, 0, v32
  s_and_b64 exec, exec, vcc
  s_cbranch_execz L_h2ok
  s_add_u32 s88, s88, 1
  s_cmp_gt_u32 s88, 100000
  s_cbranch_scc0 L_h2poll
L_h2ok:
  s_mov_b64 exec, -1
  v_pk_add_f32 v[16:17], v[16:17], v[20:21]
  v_pk_add_f32 v[24:25], v[24:25], v[28:29]
  v_pk_add_f32 v[16:17], v[16:17], v[24:25]
  s_nop 1
  v_add_f32_dpp v16, v16, v16 row_ror:8 row_mask:0xf bank_mask:0xf
  v_add_f32_dpp v17, v17, v17 row_ror:8 row_mask:0xf bank_mask:0xf
  s_nop 1
  v_permlane16_swap_b32 v16, v17
  v_add_f32 v16, v16, v17
  v_mov_b32 v18, v16
  s_nop 1
  v_permlane32_swap_b32 v16, v18
  v_add_f32 v16, v16, v18
  v_cvt_pk_bf16_f32 v16, v16, v16
  s_mov_b32 exec_lo, 0x00ff00ff
  s_mov_b32 exec_hi, 0
  buffer_store_short v16, v11, s[40:43], s87 offen
  s_mov_b64 exec, -1
  s_branch L_fin
L_helper:
  s_waitcnt lgkmcnt(0)
  s_barrier
  s_setprio 3
  s_load_dword s89, s[18:19], 0
  s_sub_u32 s56, s44, 4
  s_mov_b32 s28, s18
  s_mov_b32 s29, s19
  s_mov_b32 s30, 0x20000000
  s_mov_b32 s31, 0x20000
  s_and_b32 s40, s46, 7
  s_lshr_b32 s41, s46, 3
  s_cmp_eq_u32 s43, 0
  s_cbranch_scc1 L_noprod
  s_mov_b32 s36, s10
  s_mov_b32 s37, s11
  s_mov_b32 s38, 0x400000
  s_mov_b32 s39, 0x20000
  s_lshl3_add_u32 s48, s40, s41
  s_lshl_b32 s49, s48, 7
  s_lshl_b32 s50, s56, 20
  s_add_u32 s49, s49, s50
  v_lshrrev_b32 v6, 3, v0
  v_and_b32 v7, 7, v0
  v_lshlrev_b32 v8, 13, v6
  v_lshl_add_u32 v8, v7, 4, v8
  v_and_b32 v11, 16, v0
  v_lshlrev_b32 v11, 1, v11
  v_xor_b32 v8, v8, v11
  v_xor_b32 v11, 64, v8
  s_lshl_b32 s50, s56, 14
  s_add_u32 s50, s50, 12288
  s_add_u32 m0, s50, 0
  s_nop 0
  buffer_load_dwordx4 v8, s[36:39], s49 offen nt lds
  s_add_u32 m0, s50, 1024
  s_add_u32 s49, s49, 65536
  buffer_load_dwordx4 v11, s[36:39], s49 offen nt lds
  s_add_u32 m0, s50, 2048
  s_add_u32 s49, s49, 65536
  buffer_load_dwordx4 v8, s[36:39], s49 offen nt lds
  s_add_u32 m0, s50, 3072
  s_add_u32 s49, s49, 65536
  buffer_load_dwordx4 v11, s[36:39], s49 offen nt lds
  s_add_u32 m0, s50, 4096
  s_add_u32 s49, s49, 65536
  buffer_load_dwordx4 v8, s[36:39], s49 offen nt lds
  s_add_u32 m0, s50, 5120
  s_add_u32 s49, s49, 65536
  buffer_load_dwordx4 v11, s[36:39], s49 offen nt lds
  s_add_u32 m0, s50, 6144
  s_add_u32 s49, s49, 65536
  buffer_load_dwordx4 v8, s[36:39], s49 offen nt lds
  s_add_u32 m0, s50, 7168
  s_add_u32 s49, s49, 65536
  buffer_load_dwordx4 v11, s[36:39], s49 offen nt lds
  s_add_u32 m0, s50, 8192
  s_add_u32 s49, s49, 65536
  buffer_load_dwordx4 v8, s[36:39], s49 offen nt lds
  s_add_u32 m0, s50, 9216
  s_add_u32 s49, s49, 65536
  buffer_load_dwordx4 v11, s[36:39], s49 offen nt lds
  s_add_u32 m0, s50, 10240
  s_add_u32 s49, s49, 65536
  buffer_load_dwordx4 v8, s[36:39], s49 offen nt lds
  s_add_u32 m0, s50, 11264
  s_add_u32 s49, s49, 65536
  buffer_load_dwordx4 v11, s[36:39], s49 offen nt lds
  s_add_u32 m0, s50, 12288
  s_add_u32 s49, s49, 65536
  buffer_load_dwordx4 v8, s[36:39], s49 offen nt lds
  s_add_u32 m0, s50, 13312
  s_add_u32 s49, s49, 65536
  buffer_load_dwordx4 v11, s[36:39], s49 offen nt lds
  s_add_u32 m0, s50, 14336
  s_add_u32 s49, s49, 65536
  buffer_load_dwordx4 v8, s[36:39], s49 offen nt lds
  s_add_u32 m0, s50, 15360
  s_add_u32 s49, s49, 65536
  buffer_load_dwordx4 v11, s[36:39], s49 offen nt lds
  s_mov_b32 s32, s4
  s_mov_b32 s33, s5
  s_mov_b32 s34, 0x2000
  s_mov_b32 s35, 0x20000
  v_lshlrev_b32 v11, 10, v7
  v_lshl_add_u32 v11, v3, 4, v11
  s_lshl_b32 s51, s56, 8
  s_mov_b32 exec_lo, 0x00ff00ff
  s_mov_b32 exec_hi, 0x00ff00ff
  buffer_load_dwordx4 v[96:99], v11, s[32:35], s51 offen offset:0
  buffer_load_dwordx4 v[100:103], v11, s[32:35], s51 offen offset:64
  buffer_load_dwordx4 v[104:107], v11, s[32:35], s51 offen offset:128
  buffer_load_dwordx4 v[108:111], v11, s[32:35], s51 offen offset:192
  s_mov_b64 exec, 1
  v_mov_b32 v10, 1
  buffer_store_dword v10, v9, s[28:31], s52 offen sc1
  s_mov_b64 exec, 1
  v_mov_b32 v10, 1
  ds_add_u32 v9, v10 offset:1024
  s_mov_b64 exec, -1
  v_lshl_add_u32 v12, v3, 3, v4
  v_lshlrev_b32 v12, 7, v12
  v_lshl_add_u32 v12, v5, 3, v12
  v_add_u32 v12, s50, v12
  v_bfe_u32 v17, v0, 3, 2
  v_lshl_add_u32 v112, v17, 5, v12
  v_xor_b32 v113, 32, v112
  v_xor_b32 v114, 64, v112
  v_xor_b32 v115, 96, v112
  v_add_u32 v13, s50, v2
  s_lshl_b32 s51, s56, 10
  v_bfe_u32 v16, v0, 2, 3
  v_lshlrev_b32 v14, 8, v5
  v_lshl_add_u32 v14, v16, 4, v14
  v_add_u32 v14, s51, v14
  v_bfe_u32 v15, v0, 3, 2
  v_lshlrev_b32 v15, 15, v15
  v_lshl_add_u32 v15, v7, 4, v15
  s_lshl2_add_u32 s48, s48, s56
  s_lshl_b32 s48, s48, 7
  s_add_u32 s48, s48, 65536
  s_waitcnt vmcnt(0) lgkmcnt(0)
  ds_read_b64_tr_b16 v[128:129], v112 offset:0
  ds_read_b64_tr_b16 v[130:131], v112 offset:512
  ds_read_b64_tr_b16 v[132:133], v113 offset:0
  ds_read_b64_tr_b16 v[134:135], v113 offset:512
  ds_read_b64_tr_b16 v[136:137], v114 offset:0
  ds_read_b64_tr_b16 v[138:139], v114 offset:512
  ds_read_b64_tr_b16 v[140:141], v115 offset:0
  ds_read_b64_tr_b16 v[142:143], v115 offset:512
  ds_read_b64_tr_b16 v[144:145], v112 offset:4096
  ds_read_b64_tr_b16 v[146:147], v112 offset:4608
  ds_read_b64_tr_b16 v[148:149], v113 offset:4096
  ds_read_b64_tr_b16 v[150:151], v113 offset:4608
  ds_read_b64_tr_b16 v[152:153], v114 offset:4096
  ds_read_b64_tr_b16 v[154:155], v114 offset:4608
  ds_read_b64_tr_b16 v[156:157], v115 offset:4096
  ds_read_b64_tr_b16 v[158:159], v115 offset:4608
  ds_read_b64_tr_b16 v[160:161], v112 offset:8192
  ds_read_b64_tr_b16 v[162:163], v112 offset:8704
  ds_read_b64_tr_b16 v[164:165], v113 offset:8192
  ds_read_b64_tr_b16 v[166:167], v113 offset:8704
  ds_read_b64_tr_b16 v[168:169], v114 offset:8192
  ds_read_b64_tr_b16 v[170:171], v114 offset:8704
  ds_read_b64_tr_b16 v[172:173], v115 offset:8192
  ds_read_b64_tr_b16 v[174:175], v115 offset:8704
  ds_read_b64_tr_b16 v[176:177], v112 offset:12288
  ds_read_b64_tr_b16 v[178:179], v112 offset:12800
  ds_read_b64_tr_b16 v[180:181], v113 offset:12288
  ds_read_b64_tr_b16 v[182:183], v113 offset:12800
  ds_read_b64_tr_b16 v[184:185], v114 offset:12288
  ds_read_b64_tr_b16 v[186:187], v114 offset:12800
  ds_read_b64_tr_b16 v[188:189], v115 offset:12288
  ds_read_b64_tr_b16 v[190:191], v115 offset:12800
  s_waitcnt lgkmcnt(15)
  v_mfma_f32_16x16x32_bf16 v[16:19], v[128:131], v[96:99], 0
  s_waitcnt lgkmcnt(15)
  v_mfma_f32_16x16x32_bf16 v[20:23], v[132:135], v[96:99], 0
  s_waitcnt lgkmcnt(15)
  v_mfma_f32_16x16x32_bf16 v[24:27], v[136:139], v[96:99], 0
  s_waitcnt lgkmcnt(15)
  v_mfma_f32_16x16x32_bf16 v[28:31], v[140:143], v[96:99], 0
  s_waitcnt lgkmcnt(15)
  v_mfma_f32_16x16x32_bf16 v[16:19], v[144:147], v[100:103], v[16:19]
  s_waitcnt lgkmcnt(15)
  v_mfma_f32_16x16x32_bf16 v[20:23], v[148:151], v[100:103], v[20:23]
  s_waitcnt lgkmcnt(15)
  v_mfma_f32_16x16x32_bf16 v[24:27], v[152:155], v[100:103], v[24:27]
  s_waitcnt lgkmcnt(15)
  v_mfma_f32_16x16x32_bf16 v[28:31], v[156:159], v[100:103], v[28:31]
  s_waitcnt lgkmcnt(14)
  v_mfma_f32_16x16x32_bf16 v[16:19], v[160:163], v[104:107], v[16:19]
  s_waitcnt lgkmcnt(12)
  v_mfma_f32_16x16x32_bf16 v[20:23], v[164:167], v[104:107], v[20:23]
  s_waitcnt lgkmcnt(10)
  v_mfma_f32_16x16x32_bf16 v[24:27], v[168:171], v[104:107], v[24:27]
  s_waitcnt lgkmcnt(8)
  v_mfma_f32_16x16x32_bf16 v[28:31], v[172:175], v[104:107], v[28:31]
  s_waitcnt lgkmcnt(6)
  v_mfma_f32_16x16x32_bf16 v[16:19], v[176:179], v[108:111], v[16:19]
  s_waitcnt lgkmcnt(4)
  v_mfma_f32_16x16x32_bf16 v[20:23], v[180:183], v[108:111], v[20:23]
  s_waitcnt lgkmcnt(2)
  v_mfma_f32_16x16x32_bf16 v[24:27], v[184:187], v[108:111], v[24:27]
  s_waitcnt lgkmcnt(0)
  v_mfma_f32_16x16x32_bf16 v[28:31], v[188:191], v[108:111], v[28:31]
  s_nop 4
  ds_write_b128 v13, v[16:19] offset:0
  s_nop 0
  ds_write_b128 v13, v[20:23] offset:1024
  s_nop 0
  ds_write_b128 v13, v[24:27] offset:2048
  s_nop 0
  ds_write_b128 v13, v[28:31] offset:3072
  s_waitcnt lgkmcnt(0)
  s_mov_b64 exec, 1
  v_mov_b32 v10, 1
  ds_add_u32 v9, v10 offset:1028
  s_mov_b64 exec, -1
L_red:
  ds_read_b32 v10, v9 offset:1028
  s_waitcnt lgkmcnt(0)
  v_readfirstlane_b32 s58, v10
  s_cmp_lt_u32 s58, 4
  s_cbranch_scc1 L_red
  ds_read_b128 v[16:19], v14 offset:12288
  ds_read_b128 v[20:23], v14 offset:28672
  ds_read_b128 v[24:27], v14 offset:45056
  ds_read_b128 v[28:31], v14 offset:61440
  s_add_u32 s90, s89, 0x9e3779b1
  s_or_b32 s90, s90, 1
  s_waitcnt lgkmcnt(0)
  v_add_f32 v16, v16, v20
  v_add_f32 v24, v24, v28
  v_add_f32 v17, v17, v21
  v_add_f32 v25, v25, v29
  v_add_f32 v18, v18, v22
  v_add_f32 v26, v26, v30
  v_add_f32 v19, v19, v23
  v_add_f32 v27, v27, v31
  v_add_f32 v16, v16, v24
  v_add_f32 v17, v17, v25
  v_add_f32 v18, v18, v26
  v_add_f32 v19, v19, v27
  v_cvt_pk_bf16_f32 v20, v16, v17
  v_cvt_pk_bf16_f32 v21, v18, v19
  v_xor_b32 v22, s90, v20
  v_xor_b32 v23, s90, v21
  s_mov_b32 exec_hi, 0
  buffer_store_dwordx4 v[20:23], v15, s[28:31], s48 offen sc1
  s_mov_b64 exec, -1
L_noprod:
  s_waitcnt lgkmcnt(0)
  s_add_u32 s89, s89, 0x9e3779b1
  s_or_b32 s89, s89, 1
  s_cmp_eq_u32 s56, 0
  s_cbranch_scc1 L_h0
  s_cmp_eq_u32 s56, 1
  s_cbranch_scc1 L_h1
  s_lshl2_add_u32 s58, s2, s56
  s_cmp_eq_u32 s58, 7
  s_cbranch_scc0 L_hwaitB
  s_mov_b32 s60, 0
  s_mov_b32 s61, 0
  s_load_dword s50, s[18:19], 32768
  s_load_dword s51, s[18:19], 40960
  s_waitcnt lgkmcnt(1)
  s_memtime s[62:63]
  s_waitcnt lgkmcnt(0)
  s_memtime s[64:65]
  s_waitcnt lgkmcnt(0)
  s_sub_u32 s54, s64, s62
  s_min_u32 s54, s54, 400
  s_add_u32 s60, s60, s54
  s_load_dword s50, s[18:19], 41216
  s_load_dword s51, s[18:19], 33024
  s_waitcnt lgkmcnt(1)
  s_memtime s[62:63]
  s_waitcnt lgkmcnt(0)
  s_memtime s[64:65]
  s_waitcnt lgkmcnt(0)
  s_sub_u32 s54, s64, s62
  s_min_u32 s54, s54, 400
  s_add_u32 s61, s61, s54
  s_load_dword s50, s[18:19], 33280
  s_load_dword s51, s[18:19], 41472
  s_waitcnt lgkmcnt(1)
  s_memtime s[62:63]
  s_waitcnt lgkmcnt(0)
  s_memtime s[64:65]
  s_waitcnt lgkmcnt(0)
  s_sub_u32 s54, s64, s62
  s_min_u32 s54, s54, 400
  s_add_u32 s60, s60, s54
  s_load_dword s50, s[18:19], 41728
  s_load_dword s51, s[18:19], 33536
  s_waitcnt lgkmcnt(1)
  s_memtime s[62:63]
  s_waitcnt lgkmcnt(0)
  s_memtime s[64:65]
  s_waitcnt lgkmcnt(0)
  s_sub_u32 s54, s64, s62
  s_min_u32 s54, s54, 400
  s_add_u32 s61, s61, s54
  s_load_dword s50, s[18:19], 33792
  s_load_dword s51, s[18:19], 41984
  s_waitcnt lgkmcnt(1)
  s_memtime s[62:63]
  s_waitcnt lgkmcnt(0)
  s_memtime s[64:65]
  s_waitcnt lgkmcnt(0)
  s_sub_u32 s54, s64, s62
  s_min_u32 s54, s54, 400
  s_add_u32 s60, s60, s54
  s_load_dword s50, s[18:19], 42240
  s_load_dword s51, s[18:19], 34048
  s_waitcnt lgkmcnt(1)
  s_memtime s[62:63]
  s_waitcnt lgkmcnt(0)
  s_memtime s[64:65]
  s_waitcnt lgkmcnt(0)
  s_sub_u32 s54, s64, s62
  s_min_u32 s54, s54, 400
  s_add_u32 s61, s61, s54
  s_cmp_gt_u32 s61, s60
  s_cselect_b32 s60, 0x2000, 0
  s_andn2_b32 s61, s92, 1
  s_lshr_b32 s60, s60, 13
  s_or_b32 s60, s60, s61
  s_xor_b32 s61, s60, s89
  v_mov_b32 v16, s60
  v_mov_b32 v17, s61
  s_mov_b64 exec, 1
  buffer_store_dwordx2 v[16:17], v9, s[28:31], 0 offen offset:2048 sc1
  s_mov_b64 exec, -1
  s_branch L_hwaitB
L_h1:
L_prog1:
  s_sleep 2
  ds_read_b32 v10, v9 offset:1032
  s_waitcnt lgkmcnt(0)
  v_readfirstlane_b32 s58, v10
  s_cmp_lt_u32 s58, 1
  s_cbranch_scc1 L_prog1
  s_mov_b32 s54, 0
  s_mov_b64 exec, 1
L_cpoll:
  buffer_load_dwordx2 v[16:17], v9, s[28:31], 0 offen offset:2048 sc1
  s_waitcnt vmcnt(0)
  v_xor_b32 v18, v16, v17
  v_cmp_ne_u32 vcc, s89, v18
  s_cbranch_vccz L_cok
  s_add_u32 s54, s54, 1
  s_cmp_gt_u32 s54, 100000
  s_cbranch_scc0 L_cpoll
L_cok:
  ds_write_b32 v9, v16 offset:1048
  v_lshlrev_b32 v16, 13, v16
  v_and_b32 v16, 0x2000, v16
  ds_write_b32 v9, v16 offset:1044
  s_mov_b64 exec, -1
  s_waitcnt lgkmcnt(0)
  s_branch L_hwaitB
L_h0:
  v_lshlrev_b32 v14, 10, v5
  v_lshl_add_u32 v14, v3, 8, v14
  v_lshrrev_b32 v15, 1, v4
  v_lshl_add_u32 v14, v15, 7, v14
  v_and_b32 v15, 1, v4
  v_lshl_add_u32 v14, v15, 5, v14
  s_lshr_b32 s53, s41, 1
  s_lshl_b32 s53, s53, 15
  s_lshl_b32 s54, s40, 12
  s_add_u32 s53, s53, s54
  s_and_b32 s54, s41, 1
  s_lshl_b32 s54, s54, 6
  s_add_u32 s53, s53, s54
  s_add_u32 s53, s53, 65536
  v_mov_b32 v11, s89
  ds_write_b32 v9, v11 offset:1040
L_prog:
  s_sleep 2
  ds_read_b32 v10, v9 offset:1032
  s_waitcnt lgkmcnt(0)
  v_readfirstlane_b32 s58, v10
  s_cmp_lt_u32 s58, 1
  s_cbranch_scc1 L_prog
  s_mov_b32 s54, 0
L_qpoll:
  buffer_load_dwordx4 v[24:27], v14, s[28:31], s53 offen sc1
  buffer_load_dwordx4 v[28:31], v14, s[28:31], s53 offen offset:16 sc1
  s_waitcnt vmcnt(0)
  v_bitop3_b32 v32, v24, v26, s89 bitop3:0x96
  v_bitop3_b32 v33, v25, v27, s89 bitop3:0x96
  v_bitop3_b32 v34, v28, v30, s89 bitop3:0x96
  v_bitop3_b32 v35, v29, v31, s89 bitop3:0x96
  v_or3_b32 v36, v32, v33, v34
  v_or_b32 v36, v36, v35
  v_cmp_ne_u32 vcc, 0, v36
  s_and_b64 exec, exec, vcc
  s_cbranch_execz L_qok
  s_add_u32 s54, s54, 1
  s_cmp_gt_u32 s54, 100000
  s_cbranch_scc0 L_qpoll
L_qok:
  s_mov_b64 exec, -1
  ds_write_b64 v2, v[24:25] offset:0
  ds_write_b64 v2, v[28:29] offset:8
  s_waitcnt lgkmcnt(0)
L_hwaitB:
  s_barrier
  s_setprio 0
  ds_read_b32 v17, v9 offset:1044
  s_mov_b32 s36, s12
  s_mov_b32 s37, s13
  s_mov_b32 s38, 0x400000
  s_mov_b32 s39, 0x20000
  s_and_b32 s59, s2, 7
  s_bfe_u32 s60, s2, 0x20003
  s_lshl2_add_u32 s59, s59, s60
  s_lshr_b32 s60, s2, 5
  s_lshr_b32 s48, s59, 3
  s_lshl3_add_u32 s48, s56, s48
  s_lshl_b32 s48, s48, 17
  s_and_b32 s50, s59, 3
  s_lshl_b32 s50, s50, 15
  s_add_u32 s48, s48, s50
  s_bfe_u32 s50, s59, 0x10002
  s_lshl_b32 s50, s50, 14
  s_add_u32 s48, s48, s50
  s_lshl_b32 s50, s60, 7
  s_add_u32 s48, s48, s50
  v_bfe_u32 v6, v0, 3, 1
  v_lshlrev_b32 v6, 11, v6
  v_bfe_u32 v7, v0, 4, 1
  v_lshl_add_u32 v6, v7, 10, v6
  v_bfe_u32 v7, v0, 5, 1
  v_lshl_add_u32 v6, v7, 12, v6
  v_and_b32 v11, 7, v0
  v_lshlrev_b32 v11, 4, v11
  v_lshlrev_b32 v7, 5, v7
  v_xor_b32 v11, v11, v7
  v_add_u32 v7, v6, v11
  v_xor_b32 v6, 64, v7
  s_lshl_b32 s49, s56, 12
  s_add_u32 s49, s49, 12288
  v_lshrrev_b32 v8, 1, v3
  v_lshlrev_b32 v8, 4, v8
  v_and_b32 v11, 1, v3
  v_add_u32 v8, v8, v11
  v_lshl_add_u32 v8, v4, 2, v8
  v_lshlrev_b32 v8, 7, v8
  v_lshl_add_u32 v8, v5, 3, v8
  v_xor_b32 v11, s56, v4
  v_lshl_add_u32 v8, v11, 5, v8
  s_waitcnt lgkmcnt(0)
  v_readfirstlane_b32 s91, v17
  v_lshrrev_b32 v11, 5, v0
  v_and_b32 v13, 31, v0
  v_lshlrev_b32 v12, 16, v11
  v_bfe_u32 v16, v0, 3, 2
  v_lshl_add_u32 v12, v16, 14, v12
  v_bfe_u32 v16, v0, 2, 1
  v_lshl_add_u32 v12, v16, 12, v12
  v_lshl_add_u32 v12, v5, 4, v12
  s_lshl_b32 s53, s56, 17
  s_and_b32 s54, s59, 15
  s_lshl_b32 s54, s54, 6
  s_add_u32 s53, s53, s54
  s_lshr_b32 s54, s59, 4
  s_lshl_b32 s54, s54, 13
  s_add_u32 s53, s53, s54
  s_xor_b32 s53, s53, s91
  s_add_u32 s53, s53, 524288
  s_mul_i32 s51, s56, 544
  v_mul_u32_u24 v11, 272, v11
  v_lshl_add_u32 v13, v13, 3, v11
  v_add_u32 v13, s51, v13
  v_and_b32 v15, 1, v0
  v_lshl_add_u32 v15, v4, 1, v15
  v_mul_u32_u24 v15, 272, v15
  v_lshl_add_u32 v15, v3, 4, v15
  v_bfe_u32 v16, v0, 3, 1
  v_lshl_add_u32 v14, v3, 6, v16
  v_lshlrev_b32 v14, 12, v14
  v_and_b32 v11, 7, v0
  v_lshl_add_u32 v14, v11, 4, v14
  s_lshl2_add_u32 s55, s60, s56
  s_lshl_b32 s64, s55, 1
  s_and_b32 s64, s64, 31
  s_xor_b32 s64, s64, s59
  v_xor_b32 v16, s64, v16
  v_lshl_add_u32 v14, v16, 7, v14
  s_and_b32 s64, s55, 1
  s_bfe_u32 s65, s55, 0x10004
  s_andn2_b32 s55, s55, 0x11
  s_lshl4_add_u32 s55, s64, s55
  s_add_u32 s55, s55, s65
  s_lshl_b32 s55, s55, 13
  s_xor_b32 s55, s55, s91
  s_add_u32 s55, s55, 1048576
  s_mov_b32 s63, 0xffff0000
  s_mov_b32 s61, 0
L_wol:
  s_sleep 3
  ds_read_b32 v10, v9 offset:1036
  s_waitcnt lgkmcnt(0)
  v_readfirstlane_b32 s58, v10
  s_cmp_lt_u32 s58, 4
  s_cbranch_scc1 L_wol
  s_add_u32 m0, s49, 0
  s_nop 0
  buffer_load_dwordx4 v7, s[36:39], s48 offen nt lds
  s_add_u32 s48, s48, 8192
  s_add_u32 m0, s49, 1024
  s_nop 0
  buffer_load_dwordx4 v6, s[36:39], s48 offen nt lds
  s_add_u32 s48, s48, 516096
  s_add_u32 m0, s49, 2048
  s_nop 0
  buffer_load_dwordx4 v7, s[36:39], s48 offen nt lds
  s_add_u32 s48, s48, 8192
  s_add_u32 m0, s49, 3072
  s_nop 0
  buffer_load_dwordx4 v6, s[36:39], s48 offen nt lds
  s_add_u32 s48, s48, 8192
  s_barrier
  s_barrier
  s_sleep 10
L_h1poll:
  buffer_load_dwordx4 v[32:35], v12, s[28:31], s53 offen offset:0 sc1
  buffer_load_dwordx4 v[36:39], v12, s[28:31], s53 offen offset:1024 sc1
  buffer_load_dwordx4 v[40:43], v12, s[28:31], s53 offen offset:2048 sc1
  buffer_load_dwordx4 v[44:47], v12, s[28:31], s53 offen offset:3072 sc1
  s_waitcnt vmcnt(3)
  v_bitop3_b32 v48, v32, v33, v34 bitop3:0x96
  v_bitop3_b32 v48, v48, v35, s89 bitop3:0x96
  s_waitcnt vmcnt(2)
  v_bitop3_b32 v49, v36, v37, v38 bitop3:0x96
  v_bitop3_b32 v49, v49, v39, s89 bitop3:0x96
  s_waitcnt vmcnt(1)
  v_bitop3_b32 v50, v40, v41, v42 bitop3:0x96
  v_bitop3_b32 v50, v50, v43, s89 bitop3:0x96
  v_or3_b32 v48, v48, v49, v50
  s_waitcnt vmcnt(0)
  v_bitop3_b32 v51, v44, v45, v46 bitop3:0x96
  v_bitop3_b32 v51, v51, v47, s89 bitop3:0x96
  v_or_b32 v48, v48, v51
  v_cmp_ne_u32 vcc, 0, v48
  s_and_b64 exec, exec, vcc
  s_cbranch_execz L_h1ok
  s_add_u32 s61, s61, 1
  s_cmp_gt_u32 s61, 100000
  s_cbranch_scc0 L_h1poll
L_h1ok:
  s_mov_b64 exec, -1
  v_max3_f32 v52, v34, v38, v42
  v_max_f32 v52, v52, v46
  v_sub_f32 v48, v34, v52
  v_sub_f32 v49, v38, v52
  v_sub_f32 v50, v42, v52
  v_sub_f32 v51, v46, v52
  v_exp_f32 v48, v48
  v_and_b32 v34, s63, v32
  v_and_b32 v35, s63, v33
  v_lshlrev_b32 v32, 16, v32
  v_lshlrev_b32 v33, 16, v33
  v_exp_f32 v49, v49
  v_and_b32 v38, s63, v36
  v_and_b32 v39, s63, v37
  v_lshlrev_b32 v36, 16, v36
  v_lshlrev_b32 v37, 16, v37
  v_exp_f32 v50, v50
  v_and_b32 v42, s63, v40
  v_and_b32 v43, s63, v41
  v_lshlrev_b32 v40, 16, v40
  v_lshlrev_b32 v41, 16, v41
  v_exp_f32 v51, v51
  v_and_b32 v46, s63, v44
  v_and_b32 v47, s63, v45
  v_lshlrev_b32 v44, 16, v44
  v_lshlrev_b32 v45, 16, v45
  v_add_f32 v52, v48, v49
  v_add_f32 v53, v50, v51
  v_add_f32 v52, v52, v53
  v_rcp_f32 v52, v52
  v_pk_mul_f32 v[32:33], v[32:33], v[48:49] op_sel_hi:[1,0]
  v_pk_mul_f32 v[34:35], v[34:35], v[48:49] op_sel_hi:[1,0]
  v_pk_fma_f32 v[32:33], v[36:37], v[48:49], v[32:33] op_sel:[0,1,0] op_sel_hi:[1,1,1]
  v_pk_fma_f32 v[34:35], v[38:39], v[48:49], v[34:35] op_sel:[0,1,0] op_sel_hi:[1,1,1]
  v_pk_fma_f32 v[32:33], v[40:41], v[50:51], v[32:33] op_sel_hi:[1,0,1]
  v_pk_fma_f32 v[34:35], v[42:43], v[50:51], v[34:35] op_sel_hi:[1,0,1]
  v_pk_fma_f32 v[32:33], v[44:45], v[50:51], v[32:33] op_sel:[0,1,0] op_sel_hi:[1,1,1]
  v_pk_fma_f32 v[34:35], v[46:47], v[50:51], v[34:35] op_sel:[0,1,0] op_sel_hi:[1,1,1]
  v_pk_mul_f32 v[32:33], v[32:33], v[52:53] op_sel_hi:[1,0]
  v_pk_mul_f32 v[34:35], v[34:35], v[52:53] op_sel_hi:[1,0]
  v_cvt_pk_bf16_f32 v36, v32, v34
  v_cvt_pk_bf16_f32 v37, v33, v35
  ds_write_b64 v13, v[36:37] offset:32768
  s_waitcnt lgkmcnt(0)
  s_barrier
  ds_read_b64_tr_b16 v[96:97], v8 offset:12288
  ds_read_b64_tr_b16 v[98:99], v8 offset:12544
  ds_read_b128 v[32:35], v15 offset:32768
  ds_read_b64_tr_b16 v[100:101], v8 offset:16384
  ds_read_b64_tr_b16 v[102:103], v8 offset:16640
  ds_read_b128 v[36:39], v15 offset:32832
  ds_read_b64_tr_b16 v[104:105], v8 offset:20480
  ds_read_b64_tr_b16 v[106:107], v8 offset:20736
  ds_read_b128 v[40:43], v15 offset:32896
  ds_read_b64_tr_b16 v[108:109], v8 offset:24576
  ds_read_b64_tr_b16 v[110:111], v8 offset:24832
  ds_read_b128 v[44:47], v15 offset:32960
  s_waitcnt lgkmcnt(9)
  v_mfma_f32_16x16x32_bf16 v[68:71], v[32:35], v[96:99], 0
  s_waitcnt lgkmcnt(6)
  v_mfma_f32_16x16x32_bf16 v[68:71], v[36:39], v[100:103], v[68:71]
  s_waitcnt lgkmcnt(3)
  v_mfma_f32_16x16x32_bf16 v[68:71], v[40:43], v[104:107], v[68:71]
  s_waitcnt lgkmcnt(0)
  v_mfma_f32_16x16x32_bf16 v[68:71], v[44:47], v[108:111], v[68:71]
  s_nop 7
  v_xor_b32 v70, s89, v68
  v_xor_b32 v71, s89, v69
  buffer_store_dwordx4 v[68:71], v14, s[28:31], s55 offen sc1
L_fin:
L_end:
  s_endpgm
.section .rodata,"a"
.p2align 6
.amdhsa_kernel standalone__gqa_block_cached__sampling_kernel
  .amdhsa_next_free_vgpr 256
  .amdhsa_next_free_sgpr 96
  .amdhsa_accum_offset 256
  .amdhsa_group_segment_fixed_size 0
  .amdhsa_kernarg_size 64
  .amdhsa_float_denorm_mode_32 3
  .amdhsa_user_sgpr_count 2
  .amdhsa_user_sgpr_kernarg_segment_ptr 1
  .amdhsa_system_sgpr_workgroup_id_x 1
.end_amdhsa_kernel
```
